```python
import torch

def _softmax(x, axis=-1):
    return torch.softmax(x, dim=axis)
def _gelu(x):
    return torch.nn.functional.gelu(x, approximate="tanh")
def _silu(x):
    return torch.nn.functional.silu(x)
def _sigmoid(x):
    return torch.sigmoid(x)
def _layernorm(x, axis=-1, eps=1e-5):
    m = x.mean(dim=axis, keepdim=True)
    v = x.var(dim=axis, keepdim=True, unbiased=False)
    return (x - m) / torch.sqrt(v + eps)
def _scatter_add(tgt, idx, src, axis=0):
    return tgt.clone().index_add_(axis, idx, src)
def _segment_sum(src, seg, n):
    out = torch.zeros((n,) + src.shape[1:], dtype=src.dtype)
    return out.index_add_(0, seg, src)
def _pad(x, pw):
    flat = tuple(v for pair in reversed(pw) for v in pair)
    return torch.nn.functional.pad(x, flat)

kernel_name = 'recurrent_scan__ssm_conv_s4__glu_gated_glu__prompt'

def setup_inputs():

    _w = (lambda a: (lambda t: t.to(torch.bfloat16) if t.is_floating_point() else t)(torch.as_tensor(a)))
    def _A_setup():
        B, L, D, N = 1, 2048, 448, 256
        A_re = -(lambda _x: torch.exp(torch.as_tensor(_x)))((lambda *s: torch.randn(*s, dtype=torch.bfloat16) * 6.4)(D, N))
        A_im = torch.pi * (lambda *s: torch.randn(*s, dtype=torch.bfloat16) * 0.05)(D, N)
        B_re = (lambda *s: torch.randn(*s, dtype=torch.bfloat16) * 0.05)(D, N)
        B_im = (lambda *s: torch.randn(*s, dtype=torch.bfloat16) * 0.05)(D, N)
        C_re = (lambda *s: torch.randn(*s, dtype=torch.bfloat16) * 0.05)(D, N)
        C_im = (lambda *s: torch.randn(*s, dtype=torch.bfloat16) * 0.05)(D, N)
        log_dt = (lambda *s: torch.randn(*s, dtype=torch.bfloat16) * 0.05)(D) * 0.5 - 4.0
        Dskip = (lambda *s: torch.randn(*s, dtype=torch.bfloat16) * 0.05)(D)
        return {
            "u": _w((lambda *s: torch.randn(*s, dtype=torch.bfloat16) * 0.05)(B, L, D)),
            "A_re": _w(A_re),
            "A_im": _w(A_im),
            "B_re": _w(B_re),
            "B_im": _w(B_im),
            "C_re": _w(C_re),
            "C_im": _w(C_im),
            "log_dt": _w(log_dt),
            "Dskip": _w(Dskip),
        }
    _A_in = _A_setup()

    def _B_setup():
        B, S, D, F = 1, 2048, 448, 1792
        return {
            "x": _w((lambda *s: torch.randn(*s, dtype=torch.bfloat16) * 0.05)(B, S, D)),
            "w_gate": _w((lambda *s: torch.randn(*s, dtype=torch.bfloat16) * 0.05)(D, F)),
            "w_up": _w((lambda *s: torch.randn(*s, dtype=torch.bfloat16) * 0.05)(D, F)),
            "w_down": _w((lambda *s: torch.randn(*s, dtype=torch.bfloat16) * 0.05)(F, D)),
        }
    _B_in = _B_setup()

    return {
        "A_u": _A_in["u"],
        "A_A_re": _A_in["A_re"],
        "A_A_im": _A_in["A_im"],
        "A_B_re": _A_in["B_re"],
        "A_B_im": _A_in["B_im"],
        "A_C_re": _A_in["C_re"],
        "A_C_im": _A_in["C_im"],
        "A_log_dt": _A_in["log_dt"],
        "A_Dskip": _A_in["Dskip"],
        "B_x": _B_in["x"],
        "B_w_gate": _B_in["w_gate"],
        "B_w_up": _B_in["w_up"],
        "B_w_down": _B_in["w_down"],
    }

def reference(A_u, A_A_re, A_A_im, A_B_re, A_B_im, A_C_re, A_C_im, A_log_dt, A_Dskip, B_x, B_w_gate, B_w_up, B_w_down):
    def _A_ref(u, A_re, A_im, B_re, B_im, C_re, C_im, log_dt, Dskip):
        Bsz, L, D = u.shape
        dt = torch.exp(log_dt)[:, None]
        A = A_re + 1j * A_im
        Bc = B_re + 1j * B_im
        Cc = C_re + 1j * C_im
        logdA = dt * A
        dB = dt * Bc
        l = (lambda x, dt: x.to(dt))(torch.arange(L), A_re.dtype)
        P = torch.exp(logdA[:, :, None] * l[None, None, :])
        K = torch.einsum("dn,dnl,dn->dl", Cc, P, dB).real
        L2 = 2 * L
        Kp = _pad(K, ((0, 0), (0, L)))
        up = (lambda x, *d: x.permute(*d))(u, 0, 2, 1)
        up = _pad(up, ((0, 0), (0, 0), (0, L)))
        Kf = (lambda x, axes=(-2,-1): torch.fft.rfft2(x.float(), dim=axes))(Kp[:, None, :], axes=(-2, -1))
        Uf = (lambda x, axes=(-2,-1): torch.fft.rfft2(x.float(), dim=axes))(up[:, :, None, :], axes=(-2, -1))
        Yf = Uf * Kf[None, :, :, :]
        y = (lambda x, s, axes=(-2,-1): torch.fft.irfft2(x, s=s, dim=axes).to(torch.bfloat16))(Yf, (1, L2), axes=(-2, -1))[:, :, 0, :L]
        y = (lambda x, *d: x.permute(*d))(y, 0, 2, 1) + u * Dskip[None, None, :]
        return y

    def _B_ref(x, w_gate, w_up, w_down):
        g = torch.einsum("bsd,df->bsf", x, w_gate)
        u = torch.einsum("bsd,df->bsf", x, w_up)
        h = _sigmoid(g) * u
        return torch.einsum("bsf,fd->bsd", h, w_down)

    x = A_u
    xn = _layernorm(x, axis=-1)
    s = _A_ref(xn, A_A_re, A_A_im, A_B_re, A_B_im, A_C_re, A_C_im, A_log_dt, A_Dskip)
    g = _silu(_B_ref(xn, B_w_gate, B_w_up, B_w_down))
    return x + s * g
```

```asm
; @launch grid=(256,1,1) block=(512,1,1) lds=163840
.amdgcn_target "amdgcn-amd-amdhsa--gfx950"
.text
.globl recurrent_scan__ssm_conv_s4__glu_gated_glu__prompt_kernel
.p2align 8
.type recurrent_scan__ssm_conv_s4__glu_gated_glu__prompt_kernel,@function
recurrent_scan__ssm_conv_s4__glu_gated_glu__prompt_kernel:
  s_cmp_ge_u32 s2, 256
  s_cbranch_scc1 KEND
  s_load_dwordx2 s[4:5], s[0:1], 0
  s_load_dwordx2 s[6:7], s[0:1], 120
  s_load_dwordx8 s[8:15], s[0:1], 80
  s_getpc_b64 s[24:25]
PCREF:
  v_lshlrev_b32 v2, 6, v0
  v_min_u32 v2, CODEEND-PCREF-4, v2
  v_mov_b32 v3, s25
  v_add_co_u32 v2, vcc, s24, v2
  s_nop 1
  v_addc_co_u32 v3, vcc, 0, v3, vcc
  global_load_dword v127, v[2:3], off
  v_lshrrev_b32 v1, 6, v0
  v_and_b32 v0, 63, v0
  v_readfirstlane_b32 s3, v1
  s_and_b32 s21, s2, 7
  s_lshr_b32 s22, s2, 3
  s_cmp_lt_u32 s22, 4
  s_cbranch_scc1 SV
  s_load_dwordx16 s[36:51], s[0:1], 8
  s_sub_u32 s22, s22, 4
  s_mul_i32 s53, s21, 28
  s_add_u32 s53, s53, s22
  s_mul_i32 s55, s22, 37
  s_lshr_b32 s55, s55, 8
  s_mul_i32 s56, s55, 7
  s_sub_u32 s52, s22, s56
  s_lshl_b32 s23, s21, 2
  s_add_u32 s23, s23, s55
  s_and_b32 s22, s21, 1
  s_mul_i32 s22, s22, 7
  s_add_u32 s22, s22, s52
  s_lshr_b32 s21, s21, 1
  s_lshl_b32 s21, s21, 2
  s_add_u32 s21, s21, s55
  s_and_b32 s54, s3, 3
  v_lshrrev_b32 v4, 3, v0
  v_lshrrev_b32 v5, 4, v0
  v_and_b32 v6, 7, v0
  v_xor_b32 v6, v6, v5
  v_mul_u32_u24 v112, 896, v4
  v_lshl_add_u32 v112, v6, 4, v112
  v_xor_b32 v113, 64, v112
  v_add_u32 v113, 7168, v113
  v_and_b32 v6, 15, v0
  v_lshlrev_b32 v7, 2, v5
  v_xor_b32 v6, v6, v7
  v_mul_u32_u24 v114, 3584, v5
  v_lshl_add_u32 v114, v6, 4, v114
  v_add_u32 v115, 14336, v114
  s_mul_i32 s55, s21, 114688
  s_mul_i32 s96, s54, 14336
  s_add_u32 s55, s55, s96
  s_lshl_b32 s56, s22, 7
  s_add_u32 s56, s56, s96
  s_lshl_b32 s56, s56, 1
  s_lshl_b32 s96, s54, 11
  s_add_u32 s98, s55, 896
  s_add_u32 s99, s56, 1605632
  s_mov_b32 s59, s21
  s_lshr_b32 s97, s59, 2
  s_lshl_b32 s97, s97, 1
  s_add_u32 s97, s97, 0
  s_cmp_ge_u32 s97, 7
  s_cselect_b32 s57, 7, 0
  s_sub_u32 s97, s97, s57
  s_lshl_b32 s57, s97, 7
  s_add_u32 s55, s55, s57
  s_mul_i32 s57, s97, 229376
  s_add_u32 s56, s56, s57
  v_lshl_add_u32 v2, s54, 6, v0
  s_lshl_b32 s57, s53, 10
  v_lshl_add_u32 v3, v2, 2, s57
  s_lshl_b32 s57, s53, 2
  s_mov_b32 s26, 1835008
  s_mov_b32 s27, 0x20000
  s_mov_b32 s30, 1605632
  s_mov_b32 s31, 0x20000
  s_mov_b32 s34, 1605632
  s_mov_b32 s35, 0x20000
  s_mov_b32 s18, 16777216
  s_mov_b32 s19, 0x20000
  s_cmp_lt_u32 s3, 4
  s_waitcnt lgkmcnt(0)
  global_load_dword v120, v3, s[36:37] nt
  global_load_dword v121, v3, s[38:39] nt
  s_cbranch_scc1 P_G
  global_load_dword v122, v3, s[40:41] nt
  global_load_dword v123, v3, s[42:43] nt
  global_load_dword v124, v3, s[44:45] nt
  global_load_dword v125, v3, s[46:47] nt
P_G:
  s_load_dword s100, s[48:49], s57
  s_load_dword s101, s[50:51], s57
  s_load_dword s20, s[6:7], 0
  s_mov_b32 s24, s4
  s_and_b32 s25, s5, 0xffff
  s_mov_b32 s28, s8
  s_and_b32 s29, s9, 0xffff
  s_mov_b32 s32, s10
  s_and_b32 s33, s11, 0xffff
  s_mov_b32 s16, s6
  s_and_b32 s17, s7, 0xffff
  s_cmp_lt_u32 s3, 4
  s_cbranch_scc1 GW
AW:
  s_add_u32 m0, s96, 139264
  s_nop 0
  buffer_load_dwordx4 v114, s[32:35], s56 offen lds
  s_add_u32 m0, s96, 140288
  s_nop 0
  buffer_load_dwordx4 v115, s[32:35], s56 offen lds
  s_add_u32 m0, s96, 106496
  s_nop 0
  buffer_load_dwordx4 v114, s[28:31], s56 offen lds
  s_add_u32 m0, s96, 107520
  s_nop 0
  buffer_load_dwordx4 v115, s[28:31], s56 offen lds
  s_add_u32 s56, s56, 114688
  s_cmp_eq_u32 s56, s99
  s_cselect_b32 s57, 1605632, 0
  s_sub_u32 s56, s56, s57
  s_add_u32 s55, s55, 128
  s_cmp_eq_u32 s55, s98
  s_cselect_b32 s57, 896, 0
  s_sub_u32 s55, s55, s57
  s_lshr_b32 s48, s54, 1
  s_and_b32 s49, s54, 1
  v_and_b32 v28, 15, v0
  v_lshrrev_b32 v29, 4, v0
  v_mul_u32_u24 v5, 528, v28
  v_lshl_add_u32 v5, v29, 4, v5
  s_mul_i32 s38, s48, 32736
  s_mul_i32 s39, s49, 8448
  s_add_u32 s38, s38, s39
  s_add_u32 s38, s38, 32240
  v_add_u32 v37, s38, v5
  s_mul_i32 s45, s54, 11088
  s_cmp_eq_u32 s49, 0
  s_cselect_b32 s42, 0xfffefffe, -1
  s_mov_b32 s43, s42
  v_lshlrev_b32 v3, 4, v0
  s_cmp_ge_u32 s53, 196
  s_cselect_b32 s38, 196, 0
  s_sub_u32 s38, s53, s38
  s_mul_i32 s39, s38, 293
  s_lshr_b32 s39, s39, 11
  s_mul_i32 s40, s39, 7
  s_sub_u32 s38, s38, s40
  s_lshl_b32 s39, s39, 2
  s_add_u32 s39, s39, s54
  s_mul_i32 s36, s39, 14336
  s_lshl_b32 s40, s38, 7
  s_add_u32 s36, s36, s40
  s_add_u32 s37, s36, 7168
  s_mul_i32 s38, s38, 112
  s_add_u32 s38, s38, s39
  s_lshl_b32 s41, s38, 11
  s_add_u32 s41, s41, 4194304
  s_lshl_b32 s58, s38, 7
  s_add_u32 s58, s58, 1114112
  v_lshrrev_b32 v4, 5, v0
  v_and_b32 v5, 31, v0
  v_mul_u32_u24 v46, 3584, v4
  v_lshl_add_u32 v46, v5, 2, v46
  s_mov_b32 s8, s12
  s_and_b32 s9, s13, 0xffff
  s_mov_b32 s10, 1605632
  s_mov_b32 s11, 0x20000
  v_mov_b32 v128, 0x3f803f80
  v_mov_b32 v129, 0x3f803f80
  v_mov_b32 v130, 0x3f803f80
  v_mov_b32 v131, 0x3f803f80
  v_mov_b32 v132, 0x3f803f80
  v_mov_b32 v133, 0x3f803f80
  v_mov_b32 v134, 0x3f803f80
  v_mov_b32 v135, 0x3f803f80
  v_mov_b32 v136, 0x3f803f80
  v_mov_b32 v137, 0x3f803f80
  v_mov_b32 v138, 0x3f803f80
  v_mov_b32 v139, 0x3f803f80
  v_mov_b32 v140, 0x3f803f80
  v_mov_b32 v141, 0x3f803f80
  v_mov_b32 v142, 0x3f803f80
  v_mov_b32 v143, 0x3f803f80
  v_mov_b32 v144, 0
  v_mov_b32 v145, 0
  v_mov_b32 v146, 0
  v_mov_b32 v147, 0
  v_mov_b32 v148, 0
  v_mov_b32 v149, 0
  v_mov_b32 v150, 0
  v_mov_b32 v151, 0
  v_mov_b32 v152, 0
  v_mov_b32 v153, 0
  v_mov_b32 v154, 0
  v_mov_b32 v155, 0
  v_mov_b32 v156, 0
  v_mov_b32 v157, 0
  v_mov_b32 v158, 0
  v_mov_b32 v159, 0
  v_mov_b32 v160, 0x3f803f80
  v_mov_b32 v161, 0x3f803f80
  v_mov_b32 v162, 0x3f803f80
  v_mov_b32 v163, 0x3f803f80
  v_mov_b32 v164, 0x3f803f80
  v_mov_b32 v165, 0x3f803f80
  v_mov_b32 v166, 0x3f803f80
  v_mov_b32 v167, 0x3f803f80
  v_mov_b32 v168, 0x3f803f80
  v_mov_b32 v169, 0x3f803f80
  v_mov_b32 v170, 0x3f803f80
  v_mov_b32 v171, 0x3f803f80
  v_mov_b32 v172, 0x3f803f80
  v_mov_b32 v173, 0x3f803f80
  v_mov_b32 v174, 0x3f803f80
  v_mov_b32 v175, 0x3f803f80
  v_mov_b32 v176, 0
  v_mov_b32 v177, 0
  v_mov_b32 v178, 0
  v_mov_b32 v179, 0
  v_mov_b32 v180, 0
  v_mov_b32 v181, 0
  v_mov_b32 v182, 0
  v_mov_b32 v183, 0
  v_mov_b32 v184, 0
  v_mov_b32 v185, 0
  v_mov_b32 v186, 0
  v_mov_b32 v187, 0
  v_mov_b32 v188, 0
  v_mov_b32 v189, 0
  v_mov_b32 v190, 0
  v_mov_b32 v191, 0
  s_waitcnt lgkmcnt(0)
  s_lshr_b32 s57, s54, 1
  s_lshl_b32 s57, s57, 4
  s_lshr_b32 s100, s100, s57
  s_lshl_b32 s100, s100, 16
  s_lshr_b32 s101, s101, s57
  v_mov_b32 v126, 0x3fb8aa3b
  v_mul_f32 v126, s100, v126
  v_exp_f32 v126, v126
  s_nop 0
  v_cvt_pk_bf16_f32 v126, v126, v126
  v_and_b32 v126, 0xffff0000, v126
  s_mul_i32 s20, s20, 0x9e3779b1
  s_add_u32 s20, s20, 0x7f4a7c15
  s_lshl_b32 s46, s101, 16
  s_waitcnt vmcnt(4)
  s_add_u32 m0, s96, 147456
  s_nop 0
  buffer_load_dwordx4 v114, s[32:35], s56 offen lds
  v_lshlrev_b32 v192, 16, v120
  v_and_b32 v193, 0xffff0000, v120
  v_lshlrev_b32 v194, 16, v121
  v_and_b32 v195, 0xffff0000, v121
  v_pk_mul_f32 v[192:193], v[192:193], v[126:127] op_sel_hi:[1,0]
  v_pk_mul_f32 v[194:195], v[194:195], v[126:127] op_sel_hi:[1,0]
  v_mul_f32 v206, 0x3e22f983, v194
  v_mul_f32 v210, 0x4222f983, v194
  v_lshlrev_b32 v196, 16, v122
  v_mul_f32 v207, 0x3e22f983, v195
  s_add_u32 m0, s96, 148480
  s_nop 0
  buffer_load_dwordx4 v115, s[32:35], s56 offen lds
  v_mul_f32 v211, 0x4222f983, v195
  v_and_b32 v197, 0xffff0000, v122
  v_mul_f32 v204, 0x3fb8aa3b, v192
  v_mul_f32 v208, 0x43b8aa3b, v192
  v_lshlrev_b32 v198, 16, v123
  v_mul_f32 v205, 0x3fb8aa3b, v193
  v_mul_f32 v209, 0x43b8aa3b, v193
  v_and_b32 v199, 0xffff0000, v123
  v_fract_f32 v206, v206
  v_fract_f32 v210, v210
  s_add_u32 m0, s96, 114688
  s_nop 0
  buffer_load_dwordx4 v114, s[28:31], s56 offen lds
  v_pk_mul_f32 v[196:197], v[196:197], v[126:127] op_sel_hi:[1,0]
  v_fract_f32 v207, v207
  v_fract_f32 v211, v211
  v_pk_mul_f32 v[198:199], v[198:199], v[126:127] op_sel_hi:[1,0]
  v_exp_f32 v204, v204
  v_exp_f32 v208, v208
  v_lshlrev_b32 v200, 16, v124
  v_exp_f32 v205, v205
  v_exp_f32 v209, v209
  v_and_b32 v201, 0xffff0000, v124
  s_add_u32 m0, s96, 115712
  s_nop 0
  buffer_load_dwordx4 v115, s[28:31], s56 offen lds
  s_add_u32 s56, s56, 114688
  s_cmp_eq_u32 s56, s99
  s_cselect_b32 s57, 1605632, 0
  s_sub_u32 s56, s56, s57
  v_cos_f32 v216, v206
  v_cos_f32 v220, v210
  v_lshlrev_b32 v202, 16, v125
  v_cos_f32 v217, v207
  v_cos_f32 v221, v211
  v_and_b32 v203, 0xffff0000, v125
  v_sin_f32 v218, v206
  v_sin_f32 v222, v210
  v_pk_mul_f32 v[224:225], v[200:201], v[196:197]
  v_sin_f32 v219, v207
  s_add_u32 m0, s96, 16384
  s_nop 0
  buffer_load_dwordx4 v112, s[24:27], s55 offen lds
  v_sin_f32 v223, v211
  v_pk_mul_f32 v[226:227], v[200:201], v[198:199]
  v_pk_mul_f32 v[216:217], v[216:217], v[204:205]
  v_pk_mul_f32 v[220:221], v[220:221], v[208:209]
  v_pk_fma_f32 v[224:225], v[202:203], v[198:199], v[224:225] neg_lo:[1,0,0] neg_hi:[1,0,0]
  v_pk_mul_f32 v[218:219], v[218:219], v[204:205]
  v_pk_mul_f32 v[222:223], v[222:223], v[208:209]
  v_pk_fma_f32 v[226:227], v[202:203], v[196:197], v[226:227]
  v_cvt_pk_bf16_f32 v48, v224, v225
  v_pk_mul_f32 v[192:193], v[224:225], v[220:221]
  s_add_u32 m0, s96, 17408
  s_nop 0
  buffer_load_dwordx4 v113, s[24:27], s55 offen lds
  v_cvt_pk_bf16_f32 v69, -v226, -v227
  v_pk_mul_f32 v[194:195], v[224:225], v[222:223]
  v_pk_mul_f32 v[228:229], v[224:225], v[216:217]
  v_pk_fma_f32 v[192:193], v[226:227], v[222:223], v[192:193] neg_lo:[1,0,0] neg_hi:[1,0,0]
  v_pk_mul_f32 v[230:231], v[224:225], v[218:219]
  v_pk_fma_f32 v[194:195], v[226:227], v[220:221], v[194:195]
  v_pk_fma_f32 v[228:229], v[226:227], v[218:219], v[228:229] neg_lo:[1,0,0] neg_hi:[1,0,0]
  v_cvt_pk_bf16_f32 v56, v192, v193
  v_pk_fma_f32 v[230:231], v[226:227], v[216:217], v[230:231]
  v_cvt_pk_bf16_f32 v77, -v194, -v195
  s_add_u32 s100, s55, 57344
  s_add_u32 m0, s96, 24576
  s_nop 0
  buffer_load_dwordx4 v112, s[24:27], s100 offen lds
  v_cvt_pk_bf16_f32 v49, v228, v229
  v_pk_mul_f32 v[196:197], v[192:193], v[220:221]
  v_cvt_pk_bf16_f32 v70, -v230, -v231
  v_pk_mul_f32 v[198:199], v[192:193], v[222:223]
  v_pk_mul_f32 v[232:233], v[228:229], v[216:217]
  v_pk_fma_f32 v[196:197], v[194:195], v[222:223], v[196:197] neg_lo:[1,0,0] neg_hi:[1,0,0]
  v_pk_mul_f32 v[234:235], v[228:229], v[218:219]
  v_pk_fma_f32 v[198:199], v[194:195], v[220:221], v[198:199]
  v_pk_fma_f32 v[232:233], v[230:231], v[218:219], v[232:233] neg_lo:[1,0,0] neg_hi:[1,0,0]
  v_cvt_pk_bf16_f32 v60, v196, v197
  s_add_u32 m0, s96, 25600
  s_nop 0
  buffer_load_dwordx4 v113, s[24:27], s100 offen lds
  s_add_u32 s55, s55, 128
  s_cmp_eq_u32 s55, s98
  s_cselect_b32 s57, 896, 0
  s_sub_u32 s55, s55, s57
  v_pk_fma_f32 v[234:235], v[230:231], v[216:217], v[234:235]
  v_cvt_pk_bf16_f32 v81, -v198, -v199
  v_cvt_pk_bf16_f32 v50, v232, v233
  v_pk_mul_f32 v[192:193], v[196:197], v[220:221]
  v_cvt_pk_bf16_f32 v71, -v234, -v235
  v_pk_mul_f32 v[194:195], v[196:197], v[222:223]
  v_pk_mul_f32 v[236:237], v[232:233], v[216:217]
  v_pk_fma_f32 v[192:193], v[198:199], v[222:223], v[192:193] neg_lo:[1,0,0] neg_hi:[1,0,0]
  v_pk_mul_f32 v[238:239], v[232:233], v[218:219]
  v_pk_fma_f32 v[194:195], v[198:199], v[220:221], v[194:195]
  s_add_u32 m0, s96, 155648
  s_nop 0
  buffer_load_dwordx4 v114, s[32:35], s56 offen lds
  v_pk_fma_f32 v[236:237], v[234:235], v[218:219], v[236:237] neg_lo:[1,0,0] neg_hi:[1,0,0]
  v_cvt_pk_bf16_f32 v62, v192, v193
  v_pk_fma_f32 v[238:239], v[234:235], v[216:217], v[238:239]
  v_cvt_pk_bf16_f32 v83, -v194, -v195
  v_cvt_pk_bf16_f32 v51, v236, v237
  v_pk_mul_f32 v[196:197], v[192:193], v[220:221]
  v_cvt_pk_bf16_f32 v72, -v238, -v239
  v_pk_mul_f32 v[198:199], v[192:193], v[222:223]
  v_pk_mul_f32 v[240:241], v[236:237], v[216:217]
  v_pk_fma_f32 v[196:197], v[194:195], v[222:223], v[196:197] neg_lo:[1,0,0] neg_hi:[1,0,0]
  s_add_u32 m0, s96, 156672
  s_nop 0
  buffer_load_dwordx4 v115, s[32:35], s56 offen lds
  v_pk_mul_f32 v[242:243], v[236:237], v[218:219]
  v_pk_fma_f32 v[198:199], v[194:195], v[220:221], v[198:199]
  v_pk_fma_f32 v[240:241], v[238:239], v[218:219], v[240:241] neg_lo:[1,0,0] neg_hi:[1,0,0]
  v_cvt_pk_bf16_f32 v64, v196, v197
  v_pk_fma_f32 v[242:243], v[238:239], v[216:217], v[242:243]
  v_cvt_pk_bf16_f32 v85, -v198, -v199
  v_cvt_pk_bf16_f32 v52, v240, v241
  v_pk_mul_f32 v[192:193], v[196:197], v[220:221]
  v_cvt_pk_bf16_f32 v73, -v242, -v243
  v_pk_mul_f32 v[194:195], v[196:197], v[222:223]
  s_add_u32 m0, s96, 122880
  s_nop 0
  buffer_load_dwordx4 v114, s[28:31], s56 offen lds
  v_pk_mul_f32 v[244:245], v[240:241], v[216:217]
  v_pk_fma_f32 v[192:193], v[198:199], v[222:223], v[192:193] neg_lo:[1,0,0] neg_hi:[1,0,0]
  v_pk_mul_f32 v[246:247], v[240:241], v[218:219]
  v_pk_fma_f32 v[194:195], v[198:199], v[220:221], v[194:195]
  v_pk_fma_f32 v[244:245], v[242:243], v[218:219], v[244:245] neg_lo:[1,0,0] neg_hi:[1,0,0]
  v_cvt_pk_bf16_f32 v65, v192, v193
  v_pk_fma_f32 v[246:247], v[242:243], v[216:217], v[246:247]
  v_cvt_pk_bf16_f32 v86, -v194, -v195
  v_cvt_pk_bf16_f32 v53, v244, v245
  v_cvt_pk_bf16_f32 v74, -v246, -v247
  s_add_u32 m0, s96, 123904
  s_nop 0
  buffer_load_dwordx4 v115, s[28:31], s56 offen lds
  s_add_u32 s56, s56, 114688
  s_cmp_eq_u32 s56, s99
  s_cselect_b32 s57, 1605632, 0
  s_sub_u32 s56, s56, s57
  v_pk_mul_f32 v[248:249], v[244:245], v[216:217]
  v_pk_mul_f32 v[250:251], v[244:245], v[218:219]
  v_pk_fma_f32 v[248:249], v[246:247], v[218:219], v[248:249] neg_lo:[1,0,0] neg_hi:[1,0,0]
  v_pk_fma_f32 v[250:251], v[246:247], v[216:217], v[250:251]
  v_cvt_pk_bf16_f32 v54, v248, v249
  v_cvt_pk_bf16_f32 v75, -v250, -v251
  v_pk_mul_f32 v[252:253], v[248:249], v[216:217]
  v_pk_mul_f32 v[254:255], v[248:249], v[218:219]
  v_pk_fma_f32 v[252:253], v[250:251], v[218:219], v[252:253] neg_lo:[1,0,0] neg_hi:[1,0,0]
  v_pk_fma_f32 v[254:255], v[250:251], v[216:217], v[254:255]
  s_add_u32 m0, s96, 131072
  s_nop 0
  buffer_load_dwordx4 v114, s[32:35], s56 offen lds
  v_cvt_pk_bf16_f32 v55, v252, v253
  v_cvt_pk_bf16_f32 v76, -v254, -v255
  v_pk_mul_f32 v[200:201], v[240:241], v[220:221]
  v_pk_mul_f32 v[208:209], v[232:233], v[220:221]
  v_pk_mul_f32 v[196:197], v[192:193], v[220:221]
  v_pk_mul_f32 v[202:203], v[240:241], v[222:223]
  v_pk_mul_f32 v[210:211], v[232:233], v[222:223]
  v_pk_mul_f32 v[198:199], v[192:193], v[222:223]
  v_pk_fma_f32 v[200:201], v[242:243], v[222:223], v[200:201] neg_lo:[1,0,0] neg_hi:[1,0,0]
  v_pk_fma_f32 v[208:209], v[234:235], v[222:223], v[208:209] neg_lo:[1,0,0] neg_hi:[1,0,0]
  s_add_u32 m0, s96, 132096
  s_nop 0
  buffer_load_dwordx4 v115, s[32:35], s56 offen lds
  v_pk_fma_f32 v[196:197], v[194:195], v[222:223], v[196:197] neg_lo:[1,0,0] neg_hi:[1,0,0]
  v_pk_fma_f32 v[202:203], v[242:243], v[220:221], v[202:203]
  v_pk_fma_f32 v[210:211], v[234:235], v[220:221], v[210:211]
  v_pk_fma_f32 v[198:199], v[194:195], v[220:221], v[198:199]
  v_cvt_pk_bf16_f32 v58, v200, v201
  v_cvt_pk_bf16_f32 v57, v208, v209
  v_cvt_pk_bf16_f32 v66, v196, v197
  v_cvt_pk_bf16_f32 v79, -v202, -v203
  v_cvt_pk_bf16_f32 v78, -v210, -v211
  v_cvt_pk_bf16_f32 v87, -v198, -v199
  s_add_u32 m0, s96, 98304
  s_nop 0
  buffer_load_dwordx4 v114, s[28:31], s56 offen lds
  v_pk_mul_f32 v[204:205], v[200:201], v[220:221]
  v_pk_mul_f32 v[212:213], v[248:249], v[220:221]
  v_pk_mul_f32 v[192:193], v[196:197], v[220:221]
  v_pk_mul_f32 v[206:207], v[200:201], v[222:223]
  v_pk_mul_f32 v[214:215], v[248:249], v[222:223]
  v_pk_mul_f32 v[194:195], v[196:197], v[222:223]
  v_pk_fma_f32 v[204:205], v[202:203], v[222:223], v[204:205] neg_lo:[1,0,0] neg_hi:[1,0,0]
  v_pk_fma_f32 v[212:213], v[250:251], v[222:223], v[212:213] neg_lo:[1,0,0] neg_hi:[1,0,0]
  v_pk_fma_f32 v[192:193], v[198:199], v[222:223], v[192:193] neg_lo:[1,0,0] neg_hi:[1,0,0]
  v_pk_fma_f32 v[206:207], v[202:203], v[220:221], v[206:207]
  s_add_u32 m0, s96, 99328
  s_nop 0
  buffer_load_dwordx4 v115, s[28:31], s56 offen lds
  s_add_u32 s56, s56, 114688
  s_cmp_eq_u32 s56, s99
  s_cselect_b32 s57, 1605632, 0
  s_sub_u32 s56, s56, s57
  v_pk_fma_f32 v[214:215], v[250:251], v[220:221], v[214:215]
  v_pk_fma_f32 v[194:195], v[198:199], v[220:221], v[194:195]
  v_cvt_pk_bf16_f32 v61, v204, v205
  v_cvt_pk_bf16_f32 v59, v212, v213
  v_cvt_pk_bf16_f32 v67, v192, v193
  v_cvt_pk_bf16_f32 v82, -v206, -v207
  v_cvt_pk_bf16_f32 v80, -v214, -v215
  v_cvt_pk_bf16_f32 v88, -v194, -v195
  v_pk_mul_f32 v[200:201], v[204:205], v[220:221]
  v_pk_mul_f32 v[196:197], v[192:193], v[220:221]
  v_pk_mul_f32 v[202:203], v[204:205], v[222:223]
  v_pk_mul_f32 v[198:199], v[192:193], v[222:223]
  v_pk_fma_f32 v[200:201], v[206:207], v[222:223], v[200:201] neg_lo:[1,0,0] neg_hi:[1,0,0]
  v_pk_fma_f32 v[196:197], v[194:195], v[222:223], v[196:197] neg_lo:[1,0,0] neg_hi:[1,0,0]
  v_pk_fma_f32 v[202:203], v[206:207], v[220:221], v[202:203]
  v_pk_fma_f32 v[198:199], v[194:195], v[220:221], v[198:199]
  v_cvt_pk_bf16_f32 v63, v200, v201
  v_cvt_pk_bf16_f32 v68, v196, v197
  v_cvt_pk_bf16_f32 v84, -v202, -v203
  v_cvt_pk_bf16_f32 v89, -v198, -v199
  s_waitcnt vmcnt(16)
  s_barrier
  s_mov_b64 exec, s[42:43]
  ds_read_b128 v[128:131], v37 offset:0
  ds_read_b128 v[132:135], v37 offset:64
  ds_read_b128 v[136:139], v37 offset:128
  ds_read_b128 v[140:143], v37 offset:192
  ds_read_b128 v[144:147], v37 offset:256
  ds_read_b128 v[148:151], v37 offset:320
  ds_read_b128 v[152:155], v37 offset:384
  ds_read_b128 v[156:159], v37 offset:448
  ds_read_b128 v[160:163], v37 offset:16368
  ds_read_b128 v[164:167], v37 offset:16432
  ds_read_b128 v[168:171], v37 offset:16496
  ds_read_b128 v[172:175], v37 offset:16560
  ds_read_b128 v[176:179], v37 offset:16624
  ds_read_b128 v[180:183], v37 offset:16688
  ds_read_b128 v[184:187], v37 offset:16752
  ds_read_b128 v[188:191], v37 offset:16816
  s_mov_b64 exec, -1
  buffer_load_dword v96, v46, s[8:11], s36 offen offset:0 nt
  buffer_load_dword v97, v46, s[8:11], s36 offen offset:896 nt
  buffer_load_dword v98, v46, s[8:11], s36 offen offset:1792 nt
  buffer_load_dword v99, v46, s[8:11], s36 offen offset:2688 nt
  buffer_load_dword v100, v46, s[8:11], s37 offen offset:0 nt
  buffer_load_dword v101, v46, s[8:11], s37 offen offset:896 nt
  buffer_load_dword v102, v46, s[8:11], s37 offen offset:1792 nt
  buffer_load_dword v103, v46, s[8:11], s37 offen offset:2688 nt
  s_waitcnt vmcnt(20)
  s_waitcnt lgkmcnt(0)
  s_barrier
  s_add_u32 m0, s96, 139264
  s_nop 0
  buffer_load_dwordx4 v114, s[32:35], s56 offen lds
  s_add_u32 m0, s96, 140288
  s_nop 0
  buffer_load_dwordx4 v115, s[32:35], s56 offen lds
  s_lshl_b32 s38, s3, 2
  s_add_u32 s38, s38, 97664
  v_mov_b32 v14, s38
  v_and_b32 v15, 7, v0
  v_lshlrev_b32 v15, 2, v15
  s_add_u32 m0, s96, 106496
  s_nop 0
  buffer_load_dwordx4 v114, s[28:31], s56 offen lds
  s_add_u32 m0, s96, 107520
  s_nop 0
  buffer_load_dwordx4 v115, s[28:31], s56 offen lds
  s_add_u32 s56, s56, 114688
  s_cmp_eq_u32 s56, s99
  s_cselect_b32 s57, 1605632, 0
  s_sub_u32 s56, s56, s57
  v_add_u32 v15, 97664, v15
  s_mul_i32 s38, s48, 4864
  s_lshl_b32 s39, s49, 8
  s_add_u32 s38, s38, s39
  s_add_u32 s38, s38, 32784
  s_add_u32 m0, s96, 32768
  s_nop 0
  buffer_load_dwordx4 v112, s[24:27], s55 offen lds
  s_add_u32 m0, s96, 33792
  s_nop 0
  buffer_load_dwordx4 v113, s[24:27], s55 offen lds
  v_lshl_add_u32 v7, v28, 4, s38
  v_lshl_add_u32 v36, v29, 11, v7
  v_max_u32 v5, 1, v29
  v_lshlrev_b32 v6, v5, 1
  v_lshlrev_b32 v5, 9, v5
  s_add_u32 s100, s55, 57344
  s_add_u32 m0, s96, 40960
  s_nop 0
  buffer_load_dwordx4 v112, s[24:27], s100 offen lds
  s_add_u32 m0, s96, 41984
  s_nop 0
  buffer_load_dwordx4 v113, s[24:27], s100 offen lds
  s_add_u32 s55, s55, 128
  s_cmp_eq_u32 s55, s98
  s_cselect_b32 s57, 896, 0
  s_sub_u32 s55, s55, s57
  v_subrev_u32 v5, 512, v5
  v_lshlrev_b32 v8, 3, v29
  v_cmp_gt_u32 vcc, 32, v0
  s_nop 1
  v_cndmask_b32 v5, v5, v8, vcc
  v_add_u32 v32, v7, v5
  v_add_u32 v33, v32, v6
  s_waitcnt vmcnt(20)
  s_waitcnt lgkmcnt(0)
  s_barrier
  s_add_u32 m0, s96, 147456
  s_nop 0
  buffer_load_dwordx4 v114, s[32:35], s56 offen lds
  s_add_u32 m0, s96, 148480
  s_nop 0
  buffer_load_dwordx4 v115, s[32:35], s56 offen lds
  v_lshlrev_b32 v8, 1, v6
  v_mov_b32 v9, 512
  v_cmp_gt_u32 vcc, 48, v0
  s_nop 1
  v_cndmask_b32 v8, v9, v8, vcc
  v_add_u32 v34, v32, v8
  v_add_u32 v35, v33, v8
  v_mul_u32_u24 v5, 528, v28
  s_add_u32 m0, s96, 114688
  s_nop 0
  buffer_load_dwordx4 v114, s[28:31], s56 offen lds
  s_add_u32 m0, s96, 115712
  s_nop 0
  buffer_load_dwordx4 v115, s[28:31], s56 offen lds
  s_add_u32 s56, s56, 114688
  s_cmp_eq_u32 s56, s99
  s_cselect_b32 s57, 1605632, 0
  s_sub_u32 s56, s56, s57
  v_lshl_add_u32 v5, v29, 4, v5
  s_mul_i32 s38, s48, 22176
  s_add_u32 s38, s38, 49152
  v_add_u32 v38, s38, v5
  s_and_b32 s38, s2, 7
  s_lshl_b32 s38, s38, 12
  s_add_u32 s38, s38, 229376
  s_add_u32 m0, s96, 0
  s_nop 0
  buffer_load_dwordx4 v112, s[24:27], s55 offen lds
  s_add_u32 m0, s96, 1024
  s_nop 0
  buffer_load_dwordx4 v113, s[24:27], s55 offen lds
  v_and_b32 v5, 31, v0
  v_lshl_add_u32 v42, v5, 7, s38
  s_lshl_b32 s39, s52, 2
  s_add_u32 s39, s39, s54
  s_mul_i32 s39, s39, 3584
  s_add_u32 s39, s39, 1114112
  v_min_u32 v5, 27, v0
  v_lshl_add_u32 v39, v5, 7, s39
  s_waitcnt vmcnt(22)
  s_waitcnt lgkmcnt(0)
  s_barrier
  s_waitcnt vmcnt(14)
  s_mov_b32 s36, 0x05040100
  s_mov_b32 s37, 0x07060302
  v_perm_b32 v104, v97, v96, s36
  v_perm_b32 v105, v99, v98, s36
  v_perm_b32 v106, v101, v100, s36
  v_perm_b32 v107, v103, v102, s36
  buffer_store_dwordx4 v[104:107], v3, s[16:19], s41 offen offset:0 sc1
  v_perm_b32 v108, v97, v96, s37
  v_perm_b32 v109, v99, v98, s37
  v_perm_b32 v110, v101, v100, s37
  v_perm_b32 v111, v103, v102, s37
  buffer_store_dwordx4 v[108:111], v3, s[16:19], s41 offen offset:1024 sc1
  s_add_u32 m0, s96, 155648
  s_nop 0
  buffer_load_dwordx4 v114, s[32:35], s56 offen lds
  s_add_u32 m0, s96, 156672
  s_nop 0
  buffer_load_dwordx4 v115, s[32:35], s56 offen lds
  s_lshl_b32 s44, s54, 10
  s_add_u32 s44, s44, 32768
  s_lshl_b32 s50, s22, 15
  s_add_u32 s50, s50, 524288
  v_and_b32 v8, 31, v0
  v_lshlrev_b32 v8, 4, v8
  v_lshl_add_u32 v8, s54, 9, v8
  s_add_u32 m0, s96, 122880
  s_nop 0
  buffer_load_dwordx4 v114, s[28:31], s56 offen lds
  s_add_u32 m0, s96, 123904
  s_nop 0
  buffer_load_dwordx4 v115, s[28:31], s56 offen lds
  s_add_u32 s56, s56, 114688
  s_cmp_eq_u32 s56, s99
  s_cselect_b32 s57, 1605632, 0
  s_sub_u32 s56, s56, s57
  v_lshl_add_u32 v47, v4, 3, v8
  v_add_u32 v47, 93568, v47
  v_lshl_add_u32 v8, v4, 11, v8
  s_lshl_b32 s51, s21, 11
  s_add_u32 s51, s51, 1048576
  v_and_b32 v9, 127, v2
  v_lshlrev_b32 v9, 4, v9
  s_add_u32 s100, s55, 57344
  s_add_u32 m0, s96, 8192
  s_nop 0
  buffer_load_dwordx4 v112, s[24:27], s100 offen lds
  s_add_u32 m0, s96, 9216
  s_nop 0
  buffer_load_dwordx4 v113, s[24:27], s100 offen lds
  s_add_u32 s55, s55, 128
  s_cmp_eq_u32 s55, s98
  s_cselect_b32 s57, 896, 0
  s_sub_u32 s55, s55, s57
  v_mov_b32 v44, 0
  v_mov_b32 v45, 0
  v_mul_u32_u24 v12, 4864, v4
  v_add_u32 v12, 32776, v12
  v_lshrrev_b32 v5, 1, v2
  v_and_b32 v6, 1, v2
  v_lshlrev_b32 v40, 6, v5
  v_lshl_add_u32 v40, v6, 4, v40
  s_waitcnt vmcnt(14)
  s_waitcnt lgkmcnt(0)
  s_barrier
  s_add_u32 m0, s96, 131072
  s_nop 0
  buffer_load_dwordx4 v114, s[32:35], s56 offen lds
  s_add_u32 m0, s96, 132096
  s_nop 0
  buffer_load_dwordx4 v115, s[32:35], s56 offen lds
  v_mul_u32_u24 v6, 4608, v6
  v_lshl_add_u32 v41, v5, 4, v6
  v_add_u32 v41, 16896, v41
  s_mul_i32 s47, s48, 4608
  s_add_u32 s47, s47, 16384
  v_sub_u32 v30, 15, v28
  v_and_b32 v31, 3, v30
  s_add_u32 m0, s96, 98304
  s_nop 0
  buffer_load_dwordx4 v114, s[28:31], s56 offen lds
  s_add_u32 m0, s96, 99328
  s_nop 0
  buffer_load_dwordx4 v115, s[28:31], s56 offen lds
  s_add_u32 s56, s56, 114688
  s_cmp_eq_u32 s56, s99
  s_cselect_b32 s57, 1605632, 0
  s_sub_u32 s56, s56, s57
  v_mul_u32_u24 v31, 4160, v31
  v_lshrrev_b32 v30, 2, v30
  v_lshl_add_u32 v30, v30, 3, v31
  v_lshl_add_u32 v30, v29, 4, v30
  s_mul_i32 s38, s48, 16640
  s_lshl_b32 s39, s49, 8
  s_sub_u32 s38, s38, s39
  s_add_u32 m0, s96, 16384
  s_nop 0
  buffer_load_dwordx4 v112, s[24:27], s55 offen lds
  s_add_u32 m0, s96, 17408
  s_nop 0
  buffer_load_dwordx4 v113, s[24:27], s55 offen lds
  s_add_u32 s38, s38, 49408
  v_add_u32 v30, s38, v30
  v_lshlrev_b32 v31, 5, v28
  v_lshl_add_u32 v31, v29, 4, v31
  s_sub_u32 s38, s47, s39
  s_add_u32 s38, s38, 288
  v_add_u32 v31, s38, v31
  s_waitcnt vmcnt(16)
  s_waitcnt lgkmcnt(0)
  s_barrier
  s_waitcnt vmcnt(12)
  s_mov_b64 exec, 1
  v_mov_b32 v1, s20
  buffer_store_dword v1, off, s[16:19], s58 sc1
  s_mov_b64 exec, -1
  s_add_u32 m0, s96, 139264
  s_nop 0
  buffer_load_dwordx4 v114, s[32:35], s56 offen lds
  s_add_u32 m0, s96, 140288
  s_nop 0
  buffer_load_dwordx4 v115, s[32:35], s56 offen lds
  v_lshl_add_u32 v10, v0, 3, s47
  v_lshrrev_b32 v11, 3, v0
  v_mul_u32_u24 v11, 4160, v11
  v_and_b32 v5, 7, v0
  v_bfe_u32 v6, v0, 4, 1
  v_sub_u32 v5, v5, v6
  v_lshl_add_u32 v11, v5, 2, v11
  s_add_u32 m0, s96, 106496
  s_nop 0
  buffer_load_dwordx4 v114, s[28:31], s56 offen lds
  s_add_u32 m0, s96, 107520
  s_nop 0
  buffer_load_dwordx4 v115, s[28:31], s56 offen lds
  s_add_u32 s56, s56, 114688
  s_cmp_eq_u32 s56, s99
  s_cselect_b32 s57, 1605632, 0
  s_sub_u32 s56, s56, s57
  s_mov_b32 s38, 32784
  s_lshl_b32 s39, s54, 9
  v_lshl_add_u32 v5, v0, 1, s39
  v_sub_u32 v5, 2047, v5
  v_cvt_f32_u32 v5, v5
  v_add_f32 v6, 0x0, v5
  v_add_f32 v7, 0xbf800000, v5
  s_add_u32 s100, s55, 57344
  s_add_u32 m0, s96, 24576
  s_nop 0
  buffer_load_dwordx4 v112, s[24:27], s100 offen lds
  s_add_u32 m0, s96, 25600
  s_nop 0
  buffer_load_dwordx4 v113, s[24:27], s100 offen lds
  s_add_u32 s55, s55, 128
  s_cmp_eq_u32 s55, s98
  s_cselect_b32 s57, 896, 0
  s_sub_u32 s55, s55, s57
  v_cvt_pk_bf16_f32 v6, v6, v7
  v_and_b32 v7, 0xffff0000, v6
  v_lshlrev_b32 v6, 16, v6
  v_cvt_i32_f32 v6, v6
  v_cvt_i32_f32 v7, v7
  v_lshl_add_u32 v16, v6, 1, s38
  v_lshl_add_u32 v17, v7, 1, s38
  v_add_f32 v6, 0xc0000000, v5
  s_waitcnt vmcnt(13)
  s_waitcnt lgkmcnt(0)
  s_barrier
  s_add_u32 m0, s96, 147456
  s_nop 0
  buffer_load_dwordx4 v114, s[32:35], s56 offen lds
  s_add_u32 m0, s96, 148480
  s_nop 0
  buffer_load_dwordx4 v115, s[32:35], s56 offen lds
  v_add_f32 v7, 0xc3000000, v5
  v_cvt_pk_bf16_f32 v6, v6, v7
  v_and_b32 v7, 0xffff0000, v6
  v_lshlrev_b32 v6, 16, v6
  v_cvt_i32_f32 v6, v6
  v_cvt_i32_f32 v7, v7
  v_lshl_add_u32 v18, v6, 1, s38
  s_add_u32 m0, s96, 114688
  s_nop 0
  buffer_load_dwordx4 v114, s[28:31], s56 offen lds
  s_add_u32 m0, s96, 115712
  s_nop 0
  buffer_load_dwordx4 v115, s[28:31], s56 offen lds
  s_add_u32 s56, s56, 114688
  s_cmp_eq_u32 s56, s99
  s_cselect_b32 s57, 1605632, 0
  s_sub_u32 s56, s56, s57
  v_lshl_add_u32 v19, v7, 1, s38
  v_add_f32 v6, 0xc3010000, v5
  v_add_f32 v7, 0xc3020000, v5
  v_cvt_pk_bf16_f32 v6, v6, v7
  v_and_b32 v7, 0xffff0000, v6
  v_lshlrev_b32 v6, 16, v6
  v_cvt_i32_f32 v6, v6
  s_add_u32 m0, s96, 32768
  s_nop 0
  buffer_load_dwordx4 v112, s[24:27], s55 offen lds
  s_add_u32 m0, s96, 33792
  s_nop 0
  buffer_load_dwordx4 v113, s[24:27], s55 offen lds
  v_cvt_i32_f32 v7, v7
  v_lshl_add_u32 v20, v6, 1, s38
  v_lshl_add_u32 v21, v7, 1, s38
  v_add_f32 v6, 0xc3800000, v5
  v_add_f32 v7, 0xc3808000, v5
  v_cvt_pk_bf16_f32 v6, v6, v7
  v_and_b32 v7, 0xffff0000, v6
  v_lshlrev_b32 v6, 16, v6
  s_waitcnt vmcnt(15)
  s_waitcnt lgkmcnt(0)
  s_barrier
  s_add_u32 m0, s96, 155648
  s_nop 0
  buffer_load_dwordx4 v114, s[32:35], s56 offen lds
  s_add_u32 m0, s96, 156672
  s_nop 0
  buffer_load_dwordx4 v115, s[32:35], s56 offen lds
  v_cvt_i32_f32 v6, v6
  v_cvt_i32_f32 v7, v7
  v_lshl_add_u32 v22, v6, 1, s38
  v_lshl_add_u32 v23, v7, 1, s38
  v_add_f32 v6, 0xc3810000, v5
  v_add_f32 v7, 0xc3c00000, v5
  v_cvt_pk_bf16_f32 v6, v6, v7
  s_add_u32 m0, s96, 122880
  s_nop 0
  buffer_load_dwordx4 v114, s[28:31], s56 offen lds
  s_add_u32 m0, s96, 123904
  s_nop 0
  buffer_load_dwordx4 v115, s[28:31], s56 offen lds
  s_add_u32 s56, s56, 114688
  s_cmp_eq_u32 s56, s99
  s_cselect_b32 s57, 1605632, 0
  s_sub_u32 s56, s56, s57
  v_and_b32 v7, 0xffff0000, v6
  v_lshlrev_b32 v6, 16, v6
  v_cvt_i32_f32 v6, v6
  v_cvt_i32_f32 v7, v7
  v_lshl_add_u32 v24, v6, 1, s38
  v_lshl_add_u32 v25, v7, 1, s38
  v_add_f32 v6, 0xc3c08000, v5
  s_add_u32 s100, s55, 57344
  s_add_u32 m0, s96, 40960
  s_nop 0
  buffer_load_dwordx4 v112, s[24:27], s100 offen lds
  s_add_u32 m0, s96, 41984
  s_nop 0
  buffer_load_dwordx4 v113, s[24:27], s100 offen lds
  s_add_u32 s55, s55, 128
  s_cmp_eq_u32 s55, s98
  s_cselect_b32 s57, 896, 0
  s_sub_u32 s55, s55, s57
  v_add_f32 v7, 0xc3c10000, v5
  v_cvt_pk_bf16_f32 v6, v6, v7
  v_and_b32 v7, 0xffff0000, v6
  v_lshlrev_b32 v6, 16, v6
  v_cvt_i32_f32 v6, v6
  v_cvt_i32_f32 v7, v7
  v_lshl_add_u32 v26, v6, 1, s38
  v_lshl_add_u32 v27, v7, 1, s38
  s_waitcnt vmcnt(12)
  s_waitcnt lgkmcnt(0)
  s_barrier
  buffer_load_dword v43, v39, s[16:19], 0 offen sc1
  s_add_u32 m0, s96, 131072
  s_nop 0
  buffer_load_dwordx4 v114, s[32:35], s56 offen lds
  s_add_u32 m0, s96, 132096
  s_nop 0
  buffer_load_dwordx4 v115, s[32:35], s56 offen lds
  ds_write_b32 v15, v44
  s_add_u32 m0, s96, 98304
  s_nop 0
  buffer_load_dwordx4 v114, s[28:31], s56 offen lds
  s_add_u32 m0, s96, 99328
  s_nop 0
  buffer_load_dwordx4 v115, s[28:31], s56 offen lds
  s_add_u32 s56, s56, 114688
  s_cmp_eq_u32 s56, s99
  s_cselect_b32 s57, 1605632, 0
  s_sub_u32 s56, s56, s57
  s_add_u32 m0, s96, 0
  s_nop 0
  buffer_load_dwordx4 v112, s[24:27], s55 offen lds
  s_add_u32 m0, s96, 1024
  s_nop 0
  buffer_load_dwordx4 v113, s[24:27], s55 offen lds
  ds_write_b32 v15, v44 offset:32
  s_waitcnt vmcnt(15)
  s_waitcnt lgkmcnt(0)
  s_barrier
  s_add_u32 m0, s96, 139264
  s_nop 0
  buffer_load_dwordx4 v114, s[32:35], s56 offen lds
  s_add_u32 m0, s96, 140288
  s_nop 0
  buffer_load_dwordx4 v115, s[32:35], s56 offen lds
  s_add_u32 m0, s96, 106496
  s_nop 0
  buffer_load_dwordx4 v114, s[28:31], s56 offen lds
  s_add_u32 m0, s96, 107520
  s_nop 0
  buffer_load_dwordx4 v115, s[28:31], s56 offen lds
  s_add_u32 s56, s56, 114688
  s_cmp_eq_u32 s56, s99
  s_cselect_b32 s57, 1605632, 0
  s_sub_u32 s56, s56, s57
  s_add_u32 s100, s55, 57344
  s_add_u32 m0, s96, 8192
  s_nop 0
  buffer_load_dwordx4 v112, s[24:27], s100 offen lds
  s_add_u32 m0, s96, 9216
  s_nop 0
  buffer_load_dwordx4 v113, s[24:27], s100 offen lds
  s_add_u32 s55, s55, 128
  s_cmp_eq_u32 s55, s98
  s_cselect_b32 s57, 896, 0
  s_sub_u32 s55, s55, s57
  s_add_u32 s40, s50, 0
  buffer_load_dwordx4 v[192:195], v8, s[16:19], s40 offen sc1
  s_add_u32 s40, s50, 4096
  buffer_load_dwordx4 v[196:199], v8, s[16:19], s40 offen sc1
  s_add_u32 s40, s50, 8192
  buffer_load_dwordx4 v[200:203], v8, s[16:19], s40 offen sc1
  s_add_u32 s40, s50, 12288
  buffer_load_dwordx4 v[204:207], v8, s[16:19], s40 offen sc1
  s_waitcnt vmcnt(17)
  s_waitcnt lgkmcnt(0)
  s_barrier
  s_mov_b32 m0, s45
  s_waitcnt vmcnt(16)
  v_cmp_ne_u32 vcc, s20, v43
  s_cbranch_vccz FW_1
  s_mov_b32 s57, 0
  buffer_load_dword v43, v39, s[16:19], 0 offen sc1
  s_waitcnt vmcnt(0)
  v_cmp_ne_u32 vcc, s20, v43
  s_cbranch_vccz PD_3
PL_2:
  buffer_load_dword v43, v39, s[16:19], 0 offen sc1
  s_add_u32 s57, s57, 1
  s_waitcnt vmcnt(0)
  v_cmp_ne_u32 vcc, s20, v43
  s_cbranch_vccz PD_3
  s_cmp_lt_u32 s57, 20000
  s_cbranch_scc1 PL_2
PD_3:
FW_1:
  s_mul_i32 s36, s52, 32
  s_lshr_b32 s36, s36, 4
  s_and_b32 s58, s23, 3
  s_mul_i32 s58, s58, 3
  s_add_u32 s36, s36, s58
  s_cmp_ge_u32 s36, 14
  s_cselect_b32 s58, 14, 0
  s_sub_u32 s36, s36, s58
  s_mul_i32 s59, s52, 112
  s_mul_i32 s60, s54, 28
  s_add_u32 s59, s59, s60
  s_add_u32 s59, s59, 2062
  s_add_u32 s60, s59, 14
  s_add_u32 s61, s59, s36
  s_lshl_b32 s59, s59, 11
  s_lshl_b32 s60, s60, 11
  s_lshl_b32 s61, s61, 11
  s_add_u32 m0, s96, 147456
  s_nop 0
  buffer_load_dwordx4 v114, s[32:35], s56 offen lds
  s_add_u32 m0, s96, 148480
  s_nop 0
  buffer_load_dwordx4 v115, s[32:35], s56 offen lds
  s_mov_b32 m0, s45
  s_add_u32 m0, s96, 114688
  s_nop 0
  buffer_load_dwordx4 v114, s[28:31], s56 offen lds
  s_add_u32 m0, s96, 115712
  s_nop 0
  buffer_load_dwordx4 v115, s[28:31], s56 offen lds
  s_add_u32 s56, s56, 114688
  s_cmp_eq_u32 s56, s99
  s_cselect_b32 s57, 1605632, 0
  s_sub_u32 s56, s56, s57
  s_mov_b32 m0, s45
  s_add_u32 s40, s50, 16384
  buffer_load_dwordx4 v[208:211], v8, s[16:19], s40 offen sc1
  s_add_u32 s40, s50, 20480
  buffer_load_dwordx4 v[212:215], v8, s[16:19], s40 offen sc1
  s_add_u32 s40, s50, 24576
  buffer_load_dwordx4 v[216:219], v8, s[16:19], s40 offen sc1
  buffer_load_dwordx4 v[220:223], v9, s[16:19], s51 offen sc1
  s_mov_b32 m0, s45
  buffer_load_dword v43, v42, s[16:19], 0 offen sc1
  s_mov_b32 m0, s45
  s_waitcnt vmcnt(21)
  s_waitcnt lgkmcnt(0)
  s_barrier
  s_mov_b32 m0, s45
  buffer_load_dwordx4 v[224:227], v3, s[16:19], s61 offen offset:0
  s_mov_b32 m0, s45
  buffer_load_dwordx4 v[228:231], v3, s[16:19], s61 offen offset:1024
  s_add_u32 s61, s61, 2048
  s_cmp_eq_u32 s61, s60
  s_cselect_b32 s61, s59, s61
  s_mov_b32 m0, s45
  buffer_load_dwordx4 v[232:235], v3, s[16:19], s61 offen offset:0
  s_mov_b32 m0, s45
  buffer_load_dwordx4 v[236:239], v3, s[16:19], s61 offen offset:1024
  s_add_u32 s61, s61, 2048
  s_cmp_eq_u32 s61, s60
  s_cselect_b32 s61, s59, s61
  s_mov_b32 m0, s45
  s_waitcnt vmcnt(9)
  s_waitcnt lgkmcnt(0)
  s_barrier
  s_setprio 2
  s_lshr_b32 s41, s53, 1
  s_lshl_b32 s41, s41, 14
  s_and_b32 s42, s53, 1
  s_lshl_b32 s42, s42, 5
  s_add_u32 s41, s41, s42
  s_add_u32 s41, s41, 2097152
  s_add_u32 s42, s41, 8192
  v_or_b32 v13, 16, v15
  s_waitcnt vmcnt(5)
  s_mov_b32 s57, 0
  s_branch AC_1
AC_0:
  s_mov_b64 exec, -1
  s_add_u32 s40, s50, 0
  buffer_load_dwordx4 v[192:195], v8, s[16:19], s40 offen sc1
  s_add_u32 s40, s50, 4096
  buffer_load_dwordx4 v[196:199], v8, s[16:19], s40 offen sc1
  s_add_u32 s40, s50, 8192
  buffer_load_dwordx4 v[200:203], v8, s[16:19], s40 offen sc1
  s_add_u32 s40, s50, 12288
  buffer_load_dwordx4 v[204:207], v8, s[16:19], s40 offen sc1
  s_add_u32 s40, s50, 16384
  buffer_load_dwordx4 v[208:211], v8, s[16:19], s40 offen sc1
  s_add_u32 s40, s50, 20480
  buffer_load_dwordx4 v[212:215], v8, s[16:19], s40 offen sc1
  s_add_u32 s40, s50, 24576
  buffer_load_dwordx4 v[216:219], v8, s[16:19], s40 offen sc1
  buffer_load_dwordx4 v[220:223], v9, s[16:19], s51 offen sc1
  s_waitcnt vmcnt(0)
AC_1:
  s_add_u32 s57, s57, 1
  v_cmpx_eq_u32 vcc, s20, v193
  v_cmpx_eq_u32 vcc, s20, v195
  v_cmpx_eq_u32 vcc, s20, v197
  v_cmpx_eq_u32 vcc, s20, v199
  v_cmpx_eq_u32 vcc, s20, v201
  v_cmpx_eq_u32 vcc, s20, v203
  v_cmpx_eq_u32 vcc, s20, v205
  v_cmpx_eq_u32 vcc, s20, v207
  v_cmpx_eq_u32 vcc, s20, v209
  v_cmpx_eq_u32 vcc, s20, v211
  v_cmpx_eq_u32 vcc, s20, v213
  v_cmpx_eq_u32 vcc, s20, v215
  v_cmpx_eq_u32 vcc, s20, v217
  v_cmpx_eq_u32 vcc, s20, v219
  v_cmpx_eq_u32 vcc, s20, v223
  s_nop 1
  s_cmp_eq_u64 exec, -1
  s_cbranch_scc1 AC_2
  s_cmp_lt_u32 s57, 20000
  s_cbranch_scc1 AC_0
  s_mov_b64 exec, -1
AC_2:
  v_add_f32 v192, v192, v208
  v_add_f32 v194, v194, v210
  v_add_f32 v196, v196, v212
  v_add_f32 v198, v198, v214
  v_add_f32 v200, v200, v216
  v_add_f32 v202, v202, v218
  v_add_f32 v192, v192, v200
  v_add_f32 v194, v194, v202
  v_add_f32 v196, v196, v204
  v_add_f32 v198, v198, v206
  v_add_f32 v192, v192, v196
  v_add_f32 v194, v194, v198
  s_nop 1
  v_permlane32_swap_b32 v192, v194
  s_nop 1
  v_add_f32 v192, v192, v194
  v_add_u32 v9, 95616, v9
  ds_write_b128 v9, v[220:223]
  v_cvt_pk_bf16_f32 v90, v192, v192
  v_and_b32 v90, 0xffff0000, v90
  v_sub_f32 v91, v192, v90
  v_cvt_pk_bf16_f32 v92, v192, v91
  v_and_b32 v90, 0xffff0000, v92
  v_sub_f32 v91, v91, v90
  v_cvt_pk_bf16_f32 v93, v91, 0
  ds_write_b64 v47, v[92:93]
  s_waitcnt lgkmcnt(0)
  v_mov_b32 v1, 1
  ds_write_b32 v14, v1
  s_waitcnt vmcnt(4)
  v_cmp_ne_u32 vcc, s20, v43
  s_cbranch_vccz FX_OK
  s_mov_b32 s57, 0
  buffer_load_dword v43, v42, s[16:19], 0 offen sc1
  s_waitcnt vmcnt(0)
  v_cmp_ne_u32 vcc, s20, v43
  s_cbranch_vccz PD_5
PL_4:
  buffer_load_dword v43, v42, s[16:19], 0 offen sc1
  s_add_u32 s57, s57, 1
  s_waitcnt vmcnt(0)
  v_cmp_ne_u32 vcc, s20, v43
  s_cbranch_vccz PD_5
  s_cmp_lt_u32 s57, 20000
  s_cbranch_scc1 PL_4
PD_5:
FX_OK:
  buffer_load_dwordx4 v[112:115], v40, s[16:19], s41 offen sc1
  buffer_load_dwordx4 v[116:119], v40, s[16:19], s42 offen sc1
  buffer_load_dwordx4 v[240:243], v3, s[16:19], s61 offen offset:0
  buffer_load_dwordx4 v[244:247], v3, s[16:19], s61 offen offset:1024
  s_add_u32 s61, s61, 2048
  s_cmp_eq_u32 s61, s60
  s_cselect_b32 s61, s59, s61
  buffer_load_dwordx4 v[248:251], v3, s[16:19], s61 offen offset:0
  buffer_load_dwordx4 v[252:255], v3, s[16:19], s61 offen offset:1024
  s_add_u32 s61, s61, 2048
  s_cmp_eq_u32 s61, s60
  s_cselect_b32 s61, s59, s61
  s_setprio 0
  ds_write_addtid_b32 v48 offset:49152
  ds_write_addtid_b32 v49 offset:49680
  ds_write_addtid_b32 v50 offset:50208
  ds_write_addtid_b32 v51 offset:50736
  ds_write_addtid_b32 v52 offset:51264
  ds_write_addtid_b32 v53 offset:51792
  ds_write_addtid_b32 v54 offset:52320
  ds_write_addtid_b32 v55 offset:52848
  ds_write_addtid_b32 v56 offset:53376
  ds_write_addtid_b32 v57 offset:53904
  ds_write_addtid_b32 v58 offset:54432
  ds_write_addtid_b32 v59 offset:54960
  ds_write_addtid_b32 v60 offset:55488
  ds_write_addtid_b32 v61 offset:56016
  ds_write_addtid_b32 v62 offset:56544
  ds_write_addtid_b32 v63 offset:57072
  v_and_b32 v5, 0xffffffef, v15
  s_mov_b32 s57, 0
AS_6:
  ds_read_b32 v1, v5
  s_add_u32 s57, s57, 1
  s_waitcnt lgkmcnt(0)
  v_cmp_gt_u32 vcc, 2, v1
  s_cbranch_vccz AS_6x
  s_cmp_lt_u32 s57, 320000
  s_cbranch_scc1 AS_6
AS_6x:
  s_setprio 2
  ds_write_addtid_b32 v64 offset:57600
  ds_write_addtid_b32 v65 offset:58128
  ds_write_addtid_b32 v66 offset:58656
  ds_write_addtid_b32 v67 offset:59184
  ds_write_addtid_b32 v68 offset:59712
  ds_write_addtid_b32 v69 offset:49408
  ds_write_addtid_b32 v70 offset:49936
  ds_write_addtid_b32 v71 offset:50464
  ds_write_addtid_b32 v72 offset:50992
  ds_write_addtid_b32 v73 offset:51520
  ds_write_addtid_b32 v74 offset:52048
  ds_write_addtid_b32 v75 offset:52576
  ds_write_addtid_b32 v76 offset:53104
  ds_write_addtid_b32 v77 offset:53632
  ds_write_addtid_b32 v78 offset:54160
  ds_write_addtid_b32 v79 offset:54688
  ds_write_addtid_b32 v80 offset:55216
  ds_write_addtid_b32 v81 offset:55744
  ds_write_addtid_b32 v82 offset:56272
  ds_write_addtid_b32 v83 offset:56800
  ds_write_addtid_b32 v84 offset:57328
  ds_write_addtid_b32 v85 offset:57856
  ds_write_addtid_b32 v86 offset:58384
  ds_write_addtid_b32 v87 offset:58912
  ds_write_addtid_b32 v88 offset:59440
  ds_write_addtid_b32 v89 offset:59968
  s_waitcnt lgkmcnt(0)
  v_mov_b32 v1, 2
  ds_write_b32 v14, v1
  s_mov_b32 s57, 0
AS_7:
  ds_read_b32 v1, v15
  s_add_u32 s57, s57, 1
  s_waitcnt lgkmcnt(0)
  v_cmp_gt_u32 vcc, 2, v1
  s_cbranch_vccz AS_7x
  s_cmp_lt_u32 s57, 320000
  s_cbranch_scc1 AS_7
AS_7x:
  s_setprio 2
  buffer_load_dwordx4 v[192:195], v3, s[16:19], s61 offen offset:0
  ds_read_b128 v[48:51], v38 offset:0
  ds_read_b128 v[52:55], v38 offset:8448
  ds_read_b128 v[56:59], v38 offset:64
  ds_read_b128 v[60:63], v38 offset:8512
  ds_read_b128 v[64:67], v38 offset:128
  ds_read_b128 v[68:71], v38 offset:8576
  buffer_load_dwordx4 v[196:199], v3, s[16:19], s61 offen offset:1024
  s_add_u32 s61, s61, 2048
  s_cmp_eq_u32 s61, s60
  s_cselect_b32 s61, s59, s61
  ds_read_b128 v[72:75], v38 offset:192
  ds_read_b128 v[76:79], v38 offset:8640
  ds_read_b128 v[80:83], v38 offset:256
  ds_read_b128 v[84:87], v38 offset:8704
  ds_read_b128 v[88:91], v38 offset:320
  ds_read_b128 v[92:95], v38 offset:8768
  buffer_load_dwordx4 v[200:203], v3, s[16:19], s61 offen offset:0
  ds_read_b128 v[96:99], v38 offset:384
  ds_read_b128 v[100:103], v38 offset:8832
  ds_read_b128 v[104:107], v38 offset:448
  s_setprio 2
  s_waitcnt lgkmcnt(14)
  v_mfma_f32_16x16x32_bf16 v[120:123], v[48:51], v[128:131], 0
  s_waitcnt lgkmcnt(13)
  v_mfma_f32_16x16x32_bf16 v[124:127], v[52:55], v[128:131], 0
  ds_read_b128 v[108:111], v38 offset:8896
  buffer_load_dwordx4 v[204:207], v3, s[16:19], s61 offen offset:1024
  s_add_u32 s61, s61, 2048
  s_cmp_eq_u32 s61, s60
  s_cselect_b32 s61, s59, s61
  s_waitcnt lgkmcnt(13)
  v_mfma_f32_16x16x32_bf16 v[120:123], v[56:59], v[132:135], v[120:123]
  ds_read_b128 v[48:51], v38 offset:11088
  s_waitcnt lgkmcnt(13)
  v_mfma_f32_16x16x32_bf16 v[124:127], v[60:63], v[132:135], v[124:127]
  ds_read_b128 v[52:55], v38 offset:19536
  s_waitcnt lgkmcnt(13)
  v_mfma_f32_16x16x32_bf16 v[120:123], v[64:67], v[136:139], v[120:123]
  ds_read_b128 v[56:59], v38 offset:11152
  s_waitcnt lgkmcnt(13)
  v_mfma_f32_16x16x32_bf16 v[124:127], v[68:71], v[136:139], v[124:127]
  ds_read_b128 v[60:63], v38 offset:19600
  s_waitcnt lgkmcnt(13)
  v_mfma_f32_16x16x32_bf16 v[120:123], v[72:75], v[140:143], v[120:123]
  ds_read_b128 v[64:67], v38 offset:11216
  s_waitcnt lgkmcnt(13)
  v_mfma_f32_16x16x32_bf16 v[124:127], v[76:79], v[140:143], v[124:127]
  ds_read_b128 v[68:71], v38 offset:19664
  buffer_load_dwordx4 v[208:211], v3, s[16:19], s61 offen offset:0
  s_waitcnt lgkmcnt(13)
  v_mfma_f32_16x16x32_bf16 v[120:123], v[80:83], v[144:147], v[120:123]
  ds_read_b128 v[72:75], v38 offset:11280
  s_waitcnt lgkmcnt(13)
  v_mfma_f32_16x16x32_bf16 v[124:127], v[84:87], v[144:147], v[124:127]
  ds_read_b128 v[76:79], v38 offset:19728
  s_waitcnt lgkmcnt(13)
  v_mfma_f32_16x16x32_bf16 v[120:123], v[88:91], v[148:151], v[120:123]
  ds_read_b128 v[80:83], v38 offset:11344
  s_waitcnt lgkmcnt(13)
  v_mfma_f32_16x16x32_bf16 v[124:127], v[92:95], v[148:151], v[124:127]
  ds_read_b128 v[84:87], v38 offset:19792
  s_waitcnt lgkmcnt(13)
  v_mfma_f32_16x16x32_bf16 v[120:123], v[96:99], v[152:155], v[120:123]
  ds_read_b128 v[88:91], v38 offset:11408
  s_waitcnt lgkmcnt(13)
  v_mfma_f32_16x16x32_bf16 v[124:127], v[100:103], v[152:155], v[124:127]
  ds_read_b128 v[92:95], v38 offset:19856
  buffer_load_dwordx4 v[212:215], v3, s[16:19], s61 offen offset:1024
  s_add_u32 s61, s61, 2048
  s_cmp_eq_u32 s61, s60
  s_cselect_b32 s61, s59, s61
  s_waitcnt lgkmcnt(13)
  v_mfma_f32_16x16x32_bf16 v[120:123], v[104:107], v[156:159], v[120:123]
  ds_read_b128 v[96:99], v38 offset:11472
  s_waitcnt lgkmcnt(13)
  v_mfma_f32_16x16x32_bf16 v[124:127], v[108:111], v[156:159], v[124:127]
  ds_read_b128 v[100:103], v38 offset:19920
  s_waitcnt lgkmcnt(13)
  v_mfma_f32_16x16x32_bf16 v[120:123], v[48:51], v[160:163], v[120:123]
  ds_read_b128 v[104:107], v38 offset:11536
  s_waitcnt lgkmcnt(13)
  v_mfma_f32_16x16x32_bf16 v[124:127], v[52:55], v[160:163], v[124:127]
  ds_read_b128 v[108:111], v38 offset:19984
  s_waitcnt lgkmcnt(13)
  v_mfma_f32_16x16x32_bf16 v[120:123], v[56:59], v[164:167], v[120:123]
  s_waitcnt lgkmcnt(12)
  v_mfma_f32_16x16x32_bf16 v[124:127], v[60:63], v[164:167], v[124:127]
  buffer_load_dwordx4 v[216:219], v3, s[16:19], s61 offen offset:0
  s_waitcnt lgkmcnt(11)
  v_mfma_f32_16x16x32_bf16 v[120:123], v[64:67], v[168:171], v[120:123]
  s_waitcnt lgkmcnt(10)
  v_mfma_f32_16x16x32_bf16 v[124:127], v[68:71], v[168:171], v[124:127]
  s_waitcnt lgkmcnt(9)
  v_mfma_f32_16x16x32_bf16 v[120:123], v[72:75], v[172:175], v[120:123]
  s_waitcnt lgkmcnt(8)
  v_mfma_f32_16x16x32_bf16 v[124:127], v[76:79], v[172:175], v[124:127]
  s_waitcnt lgkmcnt(7)
  v_mfma_f32_16x16x32_bf16 v[120:123], v[80:83], v[176:179], v[120:123]
  s_waitcnt lgkmcnt(6)
  v_mfma_f32_16x16x32_bf16 v[124:127], v[84:87], v[176:179], v[124:127]
  buffer_load_dwordx4 v[220:223], v3, s[16:19], s61 offen offset:1024
  s_add_u32 s61, s61, 2048
  s_cmp_eq_u32 s61, s60
  s_cselect_b32 s61, s59, s61
  s_waitcnt lgkmcnt(5)
  v_mfma_f32_16x16x32_bf16 v[120:123], v[88:91], v[180:183], v[120:123]
  s_waitcnt lgkmcnt(4)
  v_mfma_f32_16x16x32_bf16 v[124:127], v[92:95], v[180:183], v[124:127]
  s_waitcnt lgkmcnt(3)
  v_mfma_f32_16x16x32_bf16 v[120:123], v[96:99], v[184:187], v[120:123]
  s_waitcnt lgkmcnt(2)
  v_mfma_f32_16x16x32_bf16 v[124:127], v[100:103], v[184:187], v[124:127]
  s_waitcnt lgkmcnt(1)
  v_mfma_f32_16x16x32_bf16 v[120:123], v[104:107], v[188:191], v[120:123]
  s_waitcnt lgkmcnt(0)
  v_mfma_f32_16x16x32_bf16 v[124:127], v[108:111], v[188:191], v[124:127]
  s_nop 5
  v_cvt_pk_bf16_f32 v72, v120, v121
  v_cvt_pk_bf16_f32 v73, v122, v123
  v_cvt_pk_bf16_f32 v74, v124, v125
  v_cvt_pk_bf16_f32 v75, v126, v127
  ds_write_b16 v32, v72
  ds_write_b16_d16_hi v33, v72
  ds_write_b16 v34, v73
  ds_write_b16_d16_hi v35, v73
  s_mov_b32 exec_hi, 0
  ds_write_b16 v36, v74 offset:2048
  s_mov_b32 exec_lo, 0xffff
  ds_write_b16_d16_hi v36, v74 offset:2560
  ds_write_b16 v36, v75 offset:3072
  ds_write_b16_d16_hi v36, v75 offset:3584
  s_mov_b64 exec, -1
  ds_write_b64 v12, v[44:45]
  s_mov_b32 m0, s44
  s_waitcnt lgkmcnt(0)
  v_mov_b32 v1, 3
  ds_write_b32 v14, v1
  buffer_load_dwordx4 v[184:187], v3, s[16:19], s61 offen offset:0
  buffer_load_dwordx4 v[188:191], v3, s[16:19], s61 offen offset:1024
  s_add_u32 s61, s61, 2048
  s_cmp_eq_u32 s61, s60
  s_cselect_b32 s61, s59, s61
  s_mov_b32 s57, 0
AS_8:
  ds_read_b32 v1, v13
  s_add_u32 s57, s57, 1
  s_waitcnt lgkmcnt(0)
  v_cmp_gt_u32 vcc, 3, v1
  s_cbranch_vccz AS_8x
  s_cmp_lt_u32 s57, 320000
  s_cbranch_scc1 AS_8
AS_8x:
  ds_read_u16 v48, v16 offset:0
  ds_read_u16 v49, v17 offset:0
  ds_read_u16 v50, v18 offset:0
  ds_read_u16 v51, v19 offset:0
  ds_read_u16 v52, v20 offset:0
  ds_read_u16 v53, v21 offset:0
  ds_read_u16 v54, v22 offset:0
  ds_read_u16 v55, v23 offset:0
  ds_read_u16 v56, v24 offset:0
  ds_read_u16 v57, v25 offset:0
  ds_read_u16 v58, v26 offset:0
  ds_read_u16 v59, v27 offset:0
  ds_read_u16 v60, v16 offset:4864
  ds_read_u16 v61, v17 offset:4864
  ds_read_u16 v62, v18 offset:4864
  ds_read_u16 v63, v19 offset:4864
  ds_read_u16 v64, v20 offset:4864
  ds_read_u16 v65, v21 offset:4864
  ds_read_u16 v66, v22 offset:4864
  ds_read_u16 v67, v23 offset:4864
  ds_read_u16 v68, v24 offset:4864
  ds_read_u16 v69, v25 offset:4864
  ds_read_u16 v70, v26 offset:4864
  ds_read_u16 v71, v27 offset:4864
  ds_write_b64 v10, v[44:45]
  ds_write_b32 v11, v44 offset:53248
  buffer_load_dwordx4 v[176:179], v3, s[16:19], s61 offen offset:0
  buffer_load_dwordx4 v[180:183], v3, s[16:19], s61 offen offset:1024
  s_add_u32 s61, s61, 2048
  s_cmp_eq_u32 s61, s60
  s_cselect_b32 s61, s59, s61
  s_waitcnt lgkmcnt(2)
  v_lshl_or_b32 v72, v49, 16, v48
  v_lshl_or_b32 v73, v50, 16, v49
  ds_write_addtid_b32 v72 offset:16384
  ds_write_addtid_b32 v73 offset:20544
  ds_write_addtid_b32 v72 offset:24700
  ds_write_addtid_b32 v73 offset:28860
  v_lshl_or_b32 v74, v52, 16, v51
  v_lshl_or_b32 v75, v53, 16, v52
  ds_write_addtid_b32 v74 offset:16640
  ds_write_addtid_b32 v75 offset:20800
  ds_write_addtid_b32 v74 offset:24956
  ds_write_addtid_b32 v75 offset:29116
  buffer_load_dwordx4 v[168:171], v3, s[16:19], s61 offen offset:0
  v_lshl_or_b32 v72, v55, 16, v54
  v_lshl_or_b32 v73, v56, 16, v55
  ds_write_addtid_b32 v72 offset:16896
  ds_write_addtid_b32 v73 offset:21056
  ds_write_addtid_b32 v72 offset:25212
  ds_write_addtid_b32 v73 offset:29372
  v_lshl_or_b32 v74, v58, 16, v57
  v_lshl_or_b32 v75, v59, 16, v58
  ds_write_addtid_b32 v74 offset:17152
  ds_write_addtid_b32 v75 offset:21312
  ds_write_addtid_b32 v74 offset:25468
  ds_write_addtid_b32 v75 offset:29628
  buffer_load_dwordx4 v[172:175], v3, s[16:19], s61 offen offset:1024
  s_add_u32 s61, s61, 2048
  s_cmp_eq_u32 s61, s60
  s_cselect_b32 s61, s59, s61
  v_lshl_or_b32 v76, v61, 16, v60
  v_lshl_or_b32 v77, v62, 16, v61
  ds_write_addtid_b32 v76 offset:33024
  ds_write_addtid_b32 v77 offset:37184
  ds_write_addtid_b32 v76 offset:41340
  ds_write_addtid_b32 v77 offset:45500
  v_lshl_or_b32 v78, v64, 16, v63
  v_lshl_or_b32 v79, v65, 16, v64
  ds_write_addtid_b32 v78 offset:33280
  ds_write_addtid_b32 v79 offset:37440
  ds_write_addtid_b32 v78 offset:41596
  ds_write_addtid_b32 v79 offset:45756
  buffer_load_dwordx4 v[160:163], v3, s[16:19], s61 offen offset:0
  v_lshl_or_b32 v76, v67, 16, v66
  v_lshl_or_b32 v77, v68, 16, v67
  ds_write_addtid_b32 v76 offset:33536
  ds_write_addtid_b32 v77 offset:37696
  ds_write_addtid_b32 v76 offset:41852
  ds_write_addtid_b32 v77 offset:46012
  v_lshl_or_b32 v78, v70, 16, v69
  v_lshl_or_b32 v79, v71, 16, v70
  ds_write_addtid_b32 v78 offset:33792
  ds_write_addtid_b32 v79 offset:37952
  ds_write_addtid_b32 v78 offset:42108
  ds_write_addtid_b32 v79 offset:46268
  buffer_load_dwordx4 v[164:167], v3, s[16:19], s61 offen offset:1024
  s_add_u32 s61, s61, 2048
  s_cmp_eq_u32 s61, s60
  s_cselect_b32 s61, s59, s61
  s_waitcnt vmcnt(20)
  ds_write_b128 v41, v[112:115]
  ds_write_b128 v41, v[116:119] offset:2048
  s_waitcnt vmcnt(8)
  buffer_load_dwordx4 v[152:155], v3, s[16:19], s61 offen offset:0
  s_waitcnt vmcnt(8)
  buffer_load_dwordx4 v[156:159], v3, s[16:19], s61 offen offset:1024
  s_add_u32 s61, s61, 2048
  s_cmp_eq_u32 s61, s60
  s_cselect_b32 s61, s59, s61
  s_waitcnt vmcnt(8)
  buffer_load_dwordx4 v[144:147], v3, s[16:19], s61 offen offset:0
  s_waitcnt vmcnt(8)
  buffer_load_dwordx4 v[148:151], v3, s[16:19], s61 offen offset:1024
  v_mov_b32 v8, v28
  v_mov_b32 v9, v29
  v_mov_b32 v10, v30
  v_mov_b32 v11, v31
  s_lshl_b32 s38, s54, 12
  s_add_u32 s38, s38, 32768
  v_add_u32 v6, s38, v3
  v_xor_b32 v7, 4096, v6
  v_lshlrev_b32 v12, 5, v8
  v_lshl_add_u32 v12, v9, 3, v12
  s_lshl_b32 s38, s49, 11
  s_add_u32 s38, s38, s47
  v_add_u32 v12, s38, v12
  v_lshrrev_b32 v13, 2, v8
  v_mul_u32_u24 v13, 57344, v13
  v_and_b32 v8, 3, v8
  v_lshl_add_u32 v13, v8, 5, v13
  v_lshl_add_u32 v13, v9, 3, v13
  s_lshl_b32 s39, s53, 1
  s_add_u32 s39, s39, s48
  s_mul_i32 s44, s49, 448
  s_add_u32 s44, s44, s39
  s_lshl_b32 s44, s44, 7
  s_add_u32 s44, s44, 262144
  s_mul_i32 s38, s49, 7168
  s_add_u32 s38, s38, s39
  s_lshl_b32 s38, s38, 7
  s_add_u32 s38, s38, 6291456
  v_subrev_u32 v4, 16, v14
  v_add_u32 v2, 114688, v3
  s_waitcnt lgkmcnt(0)
  v_mov_b32 v1, 4
  ds_write_b32 v14, v1
  v_or_b32 v5, 16, v15
  s_mov_b32 s57, 0
AS_9:
  ds_read_b32 v1, v15
  s_add_u32 s57, s57, 1
  s_waitcnt lgkmcnt(0)
  v_cmp_gt_u32 vcc, 4, v1
  s_cbranch_vccz AS_9x
  s_cmp_lt_u32 s57, 320000
  s_cbranch_scc1 AS_9
AS_9x:
  s_setprio 0
  ds_read_b64 v[48:49], v10 offset:3776
  ds_read_b64 v[50:51], v10 offset:3784
  ds_read_b128 v[52:55], v11 offset:192
  ds_read_b128 v[56:59], v11 offset:704
  ds_read_b128 v[60:63], v11 offset:1216
  ds_read_b128 v[64:67], v11 offset:1728
  ds_read_b128 v[68:71], v11 offset:2240
  ds_read_b128 v[72:75], v11 offset:2752
  ds_read_b128 v[76:79], v11 offset:3264
  ds_read_b128 v[80:83], v11 offset:3776
  ds_read_b64 v[84:85], v10 offset:3264
  ds_read_b64 v[86:87], v10 offset:3272
  s_waitcnt lgkmcnt(9)
  v_mfma_f32_16x16x32_bf16 v[16:19], v[48:51], v[52:55], 0
  ds_read_b64 v[88:89], v10 offset:2752
  ds_read_b64 v[90:91], v10 offset:2760
  s_waitcnt lgkmcnt(10)
  v_mfma_f32_16x16x32_bf16 v[20:23], v[48:51], v[56:59], 0
  ds_read_b64 v[92:93], v10 offset:2240
  ds_read_b64 v[94:95], v10 offset:2248
  s_waitcnt lgkmcnt(11)
  v_mfma_f32_16x16x32_bf16 v[24:27], v[48:51], v[60:63], 0
  ds_read_b64 v[96:97], v10 offset:1728
  ds_read_b64 v[98:99], v10 offset:1736
  s_waitcnt lgkmcnt(12)
  v_mfma_f32_16x16x32_bf16 v[28:31], v[48:51], v[64:67], 0
  ds_read_b64 v[100:101], v10 offset:1216
  ds_read_b64 v[102:103], v10 offset:1224
  s_waitcnt lgkmcnt(13)
  v_mfma_f32_16x16x32_bf16 v[32:35], v[48:51], v[68:71], 0
  s_waitcnt lgkmcnt(12)
  v_mfma_f32_16x16x32_bf16 v[36:39], v[48:51], v[72:75], 0
  ds_read_b64 v[104:105], v10 offset:704
  ds_read_b64 v[106:107], v10 offset:712
  s_waitcnt lgkmcnt(13)
  v_mfma_f32_16x16x32_bf16 v[40:43], v[48:51], v[76:79], 0
  s_waitcnt lgkmcnt(12)
  v_mfma_f32_16x16x32_bf16 v[44:47], v[48:51], v[80:83], 0
  ds_read_b64 v[108:109], v10 offset:192
  ds_read_b64 v[110:111], v10 offset:200
  s_waitcnt lgkmcnt(12)
  v_mfma_f32_16x16x32_bf16 v[20:23], v[84:87], v[52:55], v[20:23]
  ds_read_b64 v[112:113], v10 offset:3712
  ds_read_b64 v[114:115], v10 offset:3720
  v_mfma_f32_16x16x32_bf16 v[24:27], v[84:87], v[56:59], v[24:27]
  v_mfma_f32_16x16x32_bf16 v[28:31], v[84:87], v[60:63], v[28:31]
  v_mfma_f32_16x16x32_bf16 v[32:35], v[84:87], v[64:67], v[32:35]
  v_mfma_f32_16x16x32_bf16 v[36:39], v[84:87], v[68:71], v[36:39]
  v_mfma_f32_16x16x32_bf16 v[40:43], v[84:87], v[72:75], v[40:43]
  v_mfma_f32_16x16x32_bf16 v[44:47], v[84:87], v[76:79], v[44:47]
  s_waitcnt lgkmcnt(12)
  v_mfma_f32_16x16x32_bf16 v[24:27], v[88:91], v[52:55], v[24:27]
  ds_read_b128 v[116:119], v11 offset:128
  v_mfma_f32_16x16x32_bf16 v[28:31], v[88:91], v[56:59], v[28:31]
  v_mfma_f32_16x16x32_bf16 v[32:35], v[88:91], v[60:63], v[32:35]
  v_mfma_f32_16x16x32_bf16 v[36:39], v[88:91], v[64:67], v[36:39]
  v_mfma_f32_16x16x32_bf16 v[40:43], v[88:91], v[68:71], v[40:43]
  v_mfma_f32_16x16x32_bf16 v[44:47], v[88:91], v[72:75], v[44:47]
  s_waitcnt lgkmcnt(11)
  v_mfma_f32_16x16x32_bf16 v[28:31], v[92:95], v[52:55], v[28:31]
  ds_read_b128 v[120:123], v11 offset:640
  v_mfma_f32_16x16x32_bf16 v[32:35], v[92:95], v[56:59], v[32:35]
  ds_read_b128 v[124:127], v11 offset:1152
  v_mfma_f32_16x16x32_bf16 v[36:39], v[92:95], v[60:63], v[36:39]
  v_mfma_f32_16x16x32_bf16 v[40:43], v[92:95], v[64:67], v[40:43]
  v_mfma_f32_16x16x32_bf16 v[44:47], v[92:95], v[68:71], v[44:47]
  s_waitcnt lgkmcnt(11)
  v_mfma_f32_16x16x32_bf16 v[32:35], v[96:99], v[52:55], v[32:35]
  ds_read_b128 v[128:131], v11 offset:1664
  v_mfma_f32_16x16x32_bf16 v[36:39], v[96:99], v[56:59], v[36:39]
  ds_read_b128 v[132:135], v11 offset:2176
  v_mfma_f32_16x16x32_bf16 v[40:43], v[96:99], v[60:63], v[40:43]
  v_mfma_f32_16x16x32_bf16 v[44:47], v[96:99], v[64:67], v[44:47]
  s_waitcnt lgkmcnt(11)
  v_mfma_f32_16x16x32_bf16 v[36:39], v[100:103], v[52:55], v[36:39]
  ds_read_b128 v[136:139], v11 offset:2688
  v_mfma_f32_16x16x32_bf16 v[40:43], v[100:103], v[56:59], v[40:43]
  ds_read_b128 v[140:143], v11 offset:3200
  v_mfma_f32_16x16x32_bf16 v[44:47], v[100:103], v[60:63], v[44:47]
  s_waitcnt lgkmcnt(11)
  v_mfma_f32_16x16x32_bf16 v[40:43], v[104:107], v[52:55], v[40:43]
  ds_read_b128 v[48:51], v11 offset:3712
  v_mfma_f32_16x16x32_bf16 v[44:47], v[104:107], v[56:59], v[44:47]
  ds_read_b64 v[80:81], v10 offset:3200
  ds_read_b64 v[82:83], v10 offset:3208
  s_waitcnt lgkmcnt(12)
  v_mfma_f32_16x16x32_bf16 v[44:47], v[108:111], v[52:55], v[44:47]
  ds_read_b64 v[84:85], v10 offset:2688
  ds_read_b64 v[86:87], v10 offset:2696
  s_waitcnt lgkmcnt(11)
  v_mfma_f32_16x16x32_bf16 v[16:19], v[112:115], v[116:119], v[16:19]
  ds_read_b64 v[76:77], v10 offset:2176
  ds_read_b64 v[78:79], v10 offset:2184
  s_waitcnt lgkmcnt(12)
  v_mfma_f32_16x16x32_bf16 v[20:23], v[112:115], v[120:123], v[20:23]
  ds_read_b64 v[88:89], v10 offset:1664
  ds_read_b64 v[90:91], v10 offset:1672
  s_waitcnt lgkmcnt(13)
  v_mfma_f32_16x16x32_bf16 v[24:27], v[112:115], v[124:127], v[24:27]
  s_waitcnt lgkmcnt(12)
  v_mfma_f32_16x16x32_bf16 v[28:31], v[112:115], v[128:131], v[28:31]
  ds_read_b64 v[72:73], v10 offset:1152
  ds_read_b64 v[74:75], v10 offset:1160
  s_waitcnt lgkmcnt(13)
  v_mfma_f32_16x16x32_bf16 v[32:35], v[112:115], v[132:135], v[32:35]
  s_waitcnt lgkmcnt(12)
  v_mfma_f32_16x16x32_bf16 v[36:39], v[112:115], v[136:139], v[36:39]
  ds_read_b64 v[92:93], v10 offset:640
  ds_read_b64 v[94:95], v10 offset:648
  s_waitcnt lgkmcnt(13)
  v_mfma_f32_16x16x32_bf16 v[40:43], v[112:115], v[140:143], v[40:43]
  s_waitcnt lgkmcnt(12)
  v_mfma_f32_16x16x32_bf16 v[44:47], v[112:115], v[48:51], v[44:47]
  ds_read_b64 v[68:69], v10 offset:128
  ds_read_b64 v[70:71], v10 offset:136
  s_waitcnt lgkmcnt(12)
  v_mfma_f32_16x16x32_bf16 v[20:23], v[80:83], v[116:119], v[20:23]
  ds_read_b64 v[96:97], v10 offset:3648
  ds_read_b64 v[98:99], v10 offset:3656
  v_mfma_f32_16x16x32_bf16 v[24:27], v[80:83], v[120:123], v[24:27]
  v_mfma_f32_16x16x32_bf16 v[28:31], v[80:83], v[124:127], v[28:31]
  v_mfma_f32_16x16x32_bf16 v[32:35], v[80:83], v[128:131], v[32:35]
  v_mfma_f32_16x16x32_bf16 v[36:39], v[80:83], v[132:135], v[36:39]
  v_mfma_f32_16x16x32_bf16 v[40:43], v[80:83], v[136:139], v[40:43]
  v_mfma_f32_16x16x32_bf16 v[44:47], v[80:83], v[140:143], v[44:47]
  s_waitcnt lgkmcnt(12)
  v_mfma_f32_16x16x32_bf16 v[24:27], v[84:87], v[116:119], v[24:27]
  ds_read_b128 v[64:67], v11 offset:64
  v_mfma_f32_16x16x32_bf16 v[28:31], v[84:87], v[120:123], v[28:31]
  v_mfma_f32_16x16x32_bf16 v[32:35], v[84:87], v[124:127], v[32:35]
  v_mfma_f32_16x16x32_bf16 v[36:39], v[84:87], v[128:131], v[36:39]
  v_mfma_f32_16x16x32_bf16 v[40:43], v[84:87], v[132:135], v[40:43]
  v_mfma_f32_16x16x32_bf16 v[44:47], v[84:87], v[136:139], v[44:47]
  s_waitcnt lgkmcnt(11)
  v_mfma_f32_16x16x32_bf16 v[28:31], v[76:79], v[116:119], v[28:31]
  ds_read_b128 v[100:103], v11 offset:576
  v_mfma_f32_16x16x32_bf16 v[32:35], v[76:79], v[120:123], v[32:35]
  ds_read_b128 v[60:63], v11 offset:1088
  v_mfma_f32_16x16x32_bf16 v[36:39], v[76:79], v[124:127], v[36:39]
  v_mfma_f32_16x16x32_bf16 v[40:43], v[76:79], v[128:131], v[40:43]
  v_mfma_f32_16x16x32_bf16 v[44:47], v[76:79], v[132:135], v[44:47]
  s_waitcnt lgkmcnt(11)
  v_mfma_f32_16x16x32_bf16 v[32:35], v[88:91], v[116:119], v[32:35]
  ds_read_b128 v[104:107], v11 offset:1600
  v_mfma_f32_16x16x32_bf16 v[36:39], v[88:91], v[120:123], v[36:39]
  ds_read_b128 v[56:59], v11 offset:2112
  v_mfma_f32_16x16x32_bf16 v[40:43], v[88:91], v[124:127], v[40:43]
  v_mfma_f32_16x16x32_bf16 v[44:47], v[88:91], v[128:131], v[44:47]
  s_waitcnt lgkmcnt(11)
  v_mfma_f32_16x16x32_bf16 v[36:39], v[72:75], v[116:119], v[36:39]
  ds_read_b128 v[108:111], v11 offset:2624
  v_mfma_f32_16x16x32_bf16 v[40:43], v[72:75], v[120:123], v[40:43]
  ds_read_b128 v[52:55], v11 offset:3136
  v_mfma_f32_16x16x32_bf16 v[44:47], v[72:75], v[124:127], v[44:47]
  s_waitcnt lgkmcnt(11)
  v_mfma_f32_16x16x32_bf16 v[40:43], v[92:95], v[116:119], v[40:43]
  ds_read_b128 v[112:115], v11 offset:3648
  v_mfma_f32_16x16x32_bf16 v[44:47], v[92:95], v[120:123], v[44:47]
  ds_read_b64 v[48:49], v10 offset:3136
  ds_read_b64 v[50:51], v10 offset:3144
  s_waitcnt lgkmcnt(12)
  v_mfma_f32_16x16x32_bf16 v[44:47], v[68:71], v[116:119], v[44:47]
  ds_read_b64 v[80:81], v10 offset:2624
  ds_read_b64 v[82:83], v10 offset:2632
  s_waitcnt lgkmcnt(11)
  v_mfma_f32_16x16x32_bf16 v[16:19], v[96:99], v[64:67], v[16:19]
  ds_read_b64 v[140:141], v10 offset:2112
  ds_read_b64 v[142:143], v10 offset:2120
  s_waitcnt lgkmcnt(12)
  v_mfma_f32_16x16x32_bf16 v[20:23], v[96:99], v[100:103], v[20:23]
  ds_read_b64 v[84:85], v10 offset:1600
  ds_read_b64 v[86:87], v10 offset:1608
  s_waitcnt lgkmcnt(13)
  v_mfma_f32_16x16x32_bf16 v[24:27], v[96:99], v[60:63], v[24:27]
  s_waitcnt lgkmcnt(12)
  v_mfma_f32_16x16x32_bf16 v[28:31], v[96:99], v[104:107], v[28:31]
  ds_read_b64 v[136:137], v10 offset:1088
  ds_read_b64 v[138:139], v10 offset:1096
  s_waitcnt lgkmcnt(13)
  v_mfma_f32_16x16x32_bf16 v[32:35], v[96:99], v[56:59], v[32:35]
  s_waitcnt lgkmcnt(12)
  v_mfma_f32_16x16x32_bf16 v[36:39], v[96:99], v[108:111], v[36:39]
  ds_read_b64 v[76:77], v10 offset:576
  ds_read_b64 v[78:79], v10 offset:584
  s_waitcnt lgkmcnt(13)
  v_mfma_f32_16x16x32_bf16 v[40:43], v[96:99], v[52:55], v[40:43]
  s_waitcnt lgkmcnt(12)
  v_mfma_f32_16x16x32_bf16 v[44:47], v[96:99], v[112:115], v[44:47]
  ds_read_b64 v[132:133], v10 offset:64
  ds_read_b64 v[134:135], v10 offset:72
  s_waitcnt lgkmcnt(12)
  v_mfma_f32_16x16x32_bf16 v[20:23], v[48:51], v[64:67], v[20:23]
  ds_read_b64 v[88:89], v10 offset:3584
  ds_read_b64 v[90:91], v10 offset:3592
  v_mfma_f32_16x16x32_bf16 v[24:27], v[48:51], v[100:103], v[24:27]
  v_mfma_f32_16x16x32_bf16 v[28:31], v[48:51], v[60:63], v[28:31]
  v_mfma_f32_16x16x32_bf16 v[32:35], v[48:51], v[104:107], v[32:35]
  v_mfma_f32_16x16x32_bf16 v[36:39], v[48:51], v[56:59], v[36:39]
  v_mfma_f32_16x16x32_bf16 v[40:43], v[48:51], v[108:111], v[40:43]
  v_mfma_f32_16x16x32_bf16 v[44:47], v[48:51], v[52:55], v[44:47]
  s_waitcnt lgkmcnt(12)
  v_mfma_f32_16x16x32_bf16 v[24:27], v[80:83], v[64:67], v[24:27]
  ds_read_b128 v[128:131], v11 offset:0
  v_mfma_f32_16x16x32_bf16 v[28:31], v[80:83], v[100:103], v[28:31]
  v_mfma_f32_16x16x32_bf16 v[32:35], v[80:83], v[60:63], v[32:35]
  v_mfma_f32_16x16x32_bf16 v[36:39], v[80:83], v[104:107], v[36:39]
  v_mfma_f32_16x16x32_bf16 v[40:43], v[80:83], v[56:59], v[40:43]
  v_mfma_f32_16x16x32_bf16 v[44:47], v[80:83], v[108:111], v[44:47]
  s_waitcnt lgkmcnt(11)
  v_mfma_f32_16x16x32_bf16 v[28:31], v[140:143], v[64:67], v[28:31]
  ds_read_b128 v[72:75], v11 offset:512
  v_mfma_f32_16x16x32_bf16 v[32:35], v[140:143], v[100:103], v[32:35]
  ds_read_b128 v[124:127], v11 offset:1024
  v_mfma_f32_16x16x32_bf16 v[36:39], v[140:143], v[60:63], v[36:39]
  v_mfma_f32_16x16x32_bf16 v[40:43], v[140:143], v[104:107], v[40:43]
  v_mfma_f32_16x16x32_bf16 v[44:47], v[140:143], v[56:59], v[44:47]
  s_waitcnt lgkmcnt(11)
  v_mfma_f32_16x16x32_bf16 v[32:35], v[84:87], v[64:67], v[32:35]
  ds_read_b128 v[92:95], v11 offset:1536
  v_mfma_f32_16x16x32_bf16 v[36:39], v[84:87], v[100:103], v[36:39]
  ds_read_b128 v[120:123], v11 offset:2048
  v_mfma_f32_16x16x32_bf16 v[40:43], v[84:87], v[60:63], v[40:43]
  v_mfma_f32_16x16x32_bf16 v[44:47], v[84:87], v[104:107], v[44:47]
  s_waitcnt lgkmcnt(11)
  v_mfma_f32_16x16x32_bf16 v[36:39], v[136:139], v[64:67], v[36:39]
  ds_read_b128 v[68:71], v11 offset:2560
  v_mfma_f32_16x16x32_bf16 v[40:43], v[136:139], v[100:103], v[40:43]
  ds_read_b128 v[116:119], v11 offset:3072
  v_mfma_f32_16x16x32_bf16 v[44:47], v[136:139], v[60:63], v[44:47]
  s_waitcnt lgkmcnt(11)
  v_mfma_f32_16x16x32_bf16 v[40:43], v[76:79], v[64:67], v[40:43]
  ds_read_b128 v[96:99], v11 offset:3584
  v_mfma_f32_16x16x32_bf16 v[44:47], v[76:79], v[100:103], v[44:47]
  ds_read_b64 v[112:113], v10 offset:3072
  ds_read_b64 v[114:115], v10 offset:3080
  s_waitcnt lgkmcnt(12)
  v_mfma_f32_16x16x32_bf16 v[44:47], v[132:135], v[64:67], v[44:47]
  ds_read_b64 v[48:49], v10 offset:2560
  ds_read_b64 v[50:51], v10 offset:2568
  s_waitcnt lgkmcnt(11)
  v_mfma_f32_16x16x32_bf16 v[16:19], v[88:91], v[128:131], v[16:19]
  ds_read_b64 v[52:53], v10 offset:2048
  ds_read_b64 v[54:55], v10 offset:2056
  s_waitcnt lgkmcnt(12)
  v_mfma_f32_16x16x32_bf16 v[20:23], v[88:91], v[72:75], v[20:23]
  ds_read_b64 v[80:81], v10 offset:1536
  ds_read_b64 v[82:83], v10 offset:1544
  s_waitcnt lgkmcnt(13)
  v_mfma_f32_16x16x32_bf16 v[24:27], v[88:91], v[124:127], v[24:27]
  s_waitcnt lgkmcnt(12)
  v_mfma_f32_16x16x32_bf16 v[28:31], v[88:91], v[92:95], v[28:31]
  ds_read_b64 v[108:109], v10 offset:1024
  ds_read_b64 v[110:111], v10 offset:1032
  s_waitcnt lgkmcnt(13)
  v_mfma_f32_16x16x32_bf16 v[32:35], v[88:91], v[120:123], v[32:35]
  s_waitcnt lgkmcnt(12)
  v_mfma_f32_16x16x32_bf16 v[36:39], v[88:91], v[68:71], v[36:39]
  ds_read_b64 v[140:141], v10 offset:512
  ds_read_b64 v[142:143], v10 offset:520
  s_waitcnt lgkmcnt(13)
  v_mfma_f32_16x16x32_bf16 v[40:43], v[88:91], v[116:119], v[40:43]
  s_waitcnt lgkmcnt(12)
  v_mfma_f32_16x16x32_bf16 v[44:47], v[88:91], v[96:99], v[44:47]
  ds_read_b64 v[56:57], v10 offset:0
  ds_read_b64 v[58:59], v10 offset:8
  s_waitcnt lgkmcnt(12)
  v_mfma_f32_16x16x32_bf16 v[20:23], v[112:115], v[128:131], v[20:23]
  v_mfma_f32_16x16x32_bf16 v[24:27], v[112:115], v[72:75], v[24:27]
  v_mfma_f32_16x16x32_bf16 v[28:31], v[112:115], v[124:127], v[28:31]
  v_mfma_f32_16x16x32_bf16 v[32:35], v[112:115], v[92:95], v[32:35]
  v_mfma_f32_16x16x32_bf16 v[36:39], v[112:115], v[120:123], v[36:39]
  v_mfma_f32_16x16x32_bf16 v[40:43], v[112:115], v[68:71], v[40:43]
  v_mfma_f32_16x16x32_bf16 v[44:47], v[112:115], v[116:119], v[44:47]
  s_waitcnt lgkmcnt(10)
  v_mfma_f32_16x16x32_bf16 v[24:27], v[48:51], v[128:131], v[24:27]
  v_mfma_f32_16x16x32_bf16 v[28:31], v[48:51], v[72:75], v[28:31]
  v_mfma_f32_16x16x32_bf16 v[32:35], v[48:51], v[124:127], v[32:35]
  v_mfma_f32_16x16x32_bf16 v[36:39], v[48:51], v[92:95], v[36:39]
  v_mfma_f32_16x16x32_bf16 v[40:43], v[48:51], v[120:123], v[40:43]
  v_mfma_f32_16x16x32_bf16 v[44:47], v[48:51], v[68:71], v[44:47]
  s_waitcnt lgkmcnt(8)
  v_mfma_f32_16x16x32_bf16 v[28:31], v[52:55], v[128:131], v[28:31]
  v_mfma_f32_16x16x32_bf16 v[32:35], v[52:55], v[72:75], v[32:35]
  v_mfma_f32_16x16x32_bf16 v[36:39], v[52:55], v[124:127], v[36:39]
  v_mfma_f32_16x16x32_bf16 v[40:43], v[52:55], v[92:95], v[40:43]
  v_mfma_f32_16x16x32_bf16 v[44:47], v[52:55], v[120:123], v[44:47]
  s_waitcnt lgkmcnt(6)
  v_mfma_f32_16x16x32_bf16 v[32:35], v[80:83], v[128:131], v[32:35]
  v_mfma_f32_16x16x32_bf16 v[36:39], v[80:83], v[72:75], v[36:39]
  v_mfma_f32_16x16x32_bf16 v[40:43], v[80:83], v[124:127], v[40:43]
  v_mfma_f32_16x16x32_bf16 v[44:47], v[80:83], v[92:95], v[44:47]
  s_waitcnt lgkmcnt(4)
  v_mfma_f32_16x16x32_bf16 v[36:39], v[108:111], v[128:131], v[36:39]
  v_mfma_f32_16x16x32_bf16 v[40:43], v[108:111], v[72:75], v[40:43]
  v_mfma_f32_16x16x32_bf16 v[44:47], v[108:111], v[124:127], v[44:47]
  s_waitcnt lgkmcnt(2)
  v_mfma_f32_16x16x32_bf16 v[40:43], v[140:143], v[128:131], v[40:43]
  v_mfma_f32_16x16x32_bf16 v[44:47], v[140:143], v[72:75], v[44:47]
  s_waitcnt lgkmcnt(0)
  v_mfma_f32_16x16x32_bf16 v[44:47], v[56:59], v[128:131], v[44:47]
  s_setprio 2
  ds_read_b64 v[48:49], v12 offset:512
  ds_read_b64 v[50:51], v12 offset:1024
  ds_read_b64 v[52:53], v12 offset:1536
  ds_read_b64 v[54:55], v12 offset:2048
  s_cmp_eq_u32 s49, 0
  s_cbranch_scc1 CV_10
  v_swap_b32 v16, v32
  v_swap_b32 v17, v33
  v_swap_b32 v18, v34
  v_swap_b32 v19, v35
  v_swap_b32 v20, v36
  v_swap_b32 v21, v37
  v_swap_b32 v22, v38
  v_swap_b32 v23, v39
  v_swap_b32 v24, v40
  v_swap_b32 v25, v41
  v_swap_b32 v26, v42
  v_swap_b32 v27, v43
  v_swap_b32 v28, v44
  v_swap_b32 v29, v45
  v_swap_b32 v30, v46
  v_swap_b32 v31, v47
CV_10:
  ds_write_b128 v6, v[32:35] offset:0
  ds_write_b128 v6, v[36:39] offset:1024
  ds_write_b128 v6, v[40:43] offset:2048
  ds_write_b128 v6, v[44:47] offset:3072
  s_waitcnt lgkmcnt(0)
  v_mov_b32 v1, 5
  ds_write_b32 v14, v1
  s_mov_b32 s57, 0
AS_11:
  ds_read_b32 v1, v15
  s_add_u32 s57, s57, 1
  s_waitcnt lgkmcnt(0)
  v_cmp_gt_u32 vcc, 5, v1
  s_cbranch_vccz AS_11x
  s_cmp_lt_u32 s57, 320000
  s_cbranch_scc1 AS_11
AS_11x:
  ds_read_b128 v[32:35], v7 offset:0
  ds_read_b128 v[36:39], v7 offset:1024
  ds_read_b128 v[40:43], v7 offset:2048
  ds_read_b128 v[44:47], v7 offset:3072
  v_lshlrev_b32 v64, 16, v48
  v_and_b32 v65, 0xffff0000, v48
  v_lshlrev_b32 v66, 16, v49
  v_and_b32 v67, 0xffff0000, v49
  v_lshlrev_b32 v68, 16, v50
  v_and_b32 v69, 0xffff0000, v50
  v_lshlrev_b32 v70, 16, v51
  v_and_b32 v71, 0xffff0000, v51
  v_lshlrev_b32 v72, 16, v52
  v_and_b32 v73, 0xffff0000, v52
  v_lshlrev_b32 v74, 16, v53
  v_and_b32 v75, 0xffff0000, v53
  v_lshlrev_b32 v76, 16, v54
  v_and_b32 v77, 0xffff0000, v54
  v_lshlrev_b32 v78, 16, v55
  v_and_b32 v79, 0xffff0000, v55
  v_mul_f32 v64, s46, v64
  v_mul_f32 v65, s46, v65
  v_mul_f32 v66, s46, v66
  v_mul_f32 v67, s46, v67
  v_mul_f32 v68, s46, v68
  v_mul_f32 v69, s46, v69
  v_mul_f32 v70, s46, v70
  v_mul_f32 v71, s46, v71
  v_mul_f32 v72, s46, v72
  v_mul_f32 v73, s46, v73
  v_mul_f32 v74, s46, v74
  v_mul_f32 v75, s46, v75
  v_mul_f32 v76, s46, v76
  v_mul_f32 v77, s46, v77
  v_mul_f32 v78, s46, v78
  v_mul_f32 v79, s46, v79
  v_cvt_pk_bf16_f32 v48, v64, v65
  v_cvt_pk_bf16_f32 v49, v66, v67
  v_cvt_pk_bf16_f32 v50, v68, v69
  v_cvt_pk_bf16_f32 v51, v70, v71
  v_cvt_pk_bf16_f32 v52, v72, v73
  v_cvt_pk_bf16_f32 v53, v74, v75
  v_cvt_pk_bf16_f32 v54, v76, v77
  v_cvt_pk_bf16_f32 v55, v78, v79
  v_lshlrev_b32 v64, 16, v48
  v_and_b32 v65, 0xffff0000, v48
  v_lshlrev_b32 v66, 16, v49
  v_and_b32 v67, 0xffff0000, v49
  v_lshlrev_b32 v68, 16, v50
  v_and_b32 v69, 0xffff0000, v50
  v_lshlrev_b32 v70, 16, v51
  v_and_b32 v71, 0xffff0000, v51
  v_lshlrev_b32 v72, 16, v52
  v_and_b32 v73, 0xffff0000, v52
  v_lshlrev_b32 v74, 16, v53
  v_and_b32 v75, 0xffff0000, v53
  v_lshlrev_b32 v76, 16, v54
  v_and_b32 v77, 0xffff0000, v54
  v_lshlrev_b32 v78, 16, v55
  v_and_b32 v79, 0xffff0000, v55
  s_waitcnt lgkmcnt(0)
  v_mov_b32 v1, 6
  ds_write_b32 v14, v1
  v_add_f32 v16, v16, v32
  v_add_f32 v17, v17, v33
  v_add_f32 v18, v18, v34
  v_add_f32 v19, v19, v35
  v_add_f32 v20, v20, v36
  v_add_f32 v21, v21, v37
  v_add_f32 v22, v22, v38
  v_add_f32 v23, v23, v39
  v_add_f32 v24, v24, v40
  v_add_f32 v25, v25, v41
  v_add_f32 v26, v26, v42
  v_add_f32 v27, v27, v43
  v_add_f32 v28, v28, v44
  v_add_f32 v29, v29, v45
  v_add_f32 v30, v30, v46
  v_add_f32 v31, v31, v47
  v_cvt_pk_bf16_f32 v48, v16, v17
  v_cvt_pk_bf16_f32 v49, v18, v19
  v_cvt_pk_bf16_f32 v50, v20, v21
  v_cvt_pk_bf16_f32 v51, v22, v23
  v_cvt_pk_bf16_f32 v52, v24, v25
  v_cvt_pk_bf16_f32 v53, v26, v27
  v_cvt_pk_bf16_f32 v54, v28, v29
  v_cvt_pk_bf16_f32 v55, v30, v31
  v_lshlrev_b32 v16, 16, v48
  v_and_b32 v17, 0xffff0000, v48
  v_lshlrev_b32 v18, 16, v49
  v_and_b32 v19, 0xffff0000, v49
  v_lshlrev_b32 v20, 16, v50
  v_and_b32 v21, 0xffff0000, v50
  v_lshlrev_b32 v22, 16, v51
  v_and_b32 v23, 0xffff0000, v51
  v_lshlrev_b32 v24, 16, v52
  v_and_b32 v25, 0xffff0000, v52
  v_lshlrev_b32 v26, 16, v53
  v_and_b32 v27, 0xffff0000, v53
  v_lshlrev_b32 v28, 16, v54
  v_and_b32 v29, 0xffff0000, v54
  v_lshlrev_b32 v30, 16, v55
  v_and_b32 v31, 0xffff0000, v55
  v_add_f32 v16, v16, v64
  v_add_f32 v17, v17, v65
  v_add_f32 v18, v18, v66
  v_add_f32 v19, v19, v67
  v_add_f32 v20, v20, v68
  v_add_f32 v21, v21, v69
  v_add_f32 v22, v22, v70
  v_add_f32 v23, v23, v71
  v_add_f32 v24, v24, v72
  v_add_f32 v25, v25, v73
  v_add_f32 v26, v26, v74
  v_add_f32 v27, v27, v75
  v_add_f32 v28, v28, v76
  v_add_f32 v29, v29, v77
  v_add_f32 v30, v30, v78
  v_add_f32 v31, v31, v79
  v_cvt_pk_bf16_f32 v48, v16, v17
  v_cvt_pk_bf16_f32 v49, v18, v19
  v_cvt_pk_bf16_f32 v50, v20, v21
  v_cvt_pk_bf16_f32 v51, v22, v23
  v_cvt_pk_bf16_f32 v52, v24, v25
  v_cvt_pk_bf16_f32 v53, v26, v27
  v_cvt_pk_bf16_f32 v54, v28, v29
  v_cvt_pk_bf16_f32 v55, v30, v31
  s_add_u32 s39, s38, 0
  buffer_store_dwordx2 v[48:49], v13, s[16:19], s39 offen sc1
  s_add_u32 s39, s38, 229376
  buffer_store_dwordx2 v[50:51], v13, s[16:19], s39 offen sc1
  s_add_u32 s39, s38, 458752
  buffer_store_dwordx2 v[52:53], v13, s[16:19], s39 offen sc1
  s_add_u32 s39, s38, 688128
  buffer_store_dwordx2 v[54:55], v13, s[16:19], s39 offen sc1
  s_mov_b32 s57, 0
AS_12:
  ds_read_b32 v1, v15
  s_add_u32 s57, s57, 1
  s_waitcnt lgkmcnt(0)
  v_cmp_gt_u32 vcc, 6, v1
  s_cbranch_vccz AS_12x
  s_cmp_lt_u32 s57, 320000
  s_cbranch_scc1 AS_12
AS_12x:
  ds_read_b32 v1, v4
  s_waitcnt lgkmcnt(0)
  v_cmp_ne_u32 vcc, -1, v1
  s_cbranch_vccz A_J
  s_waitcnt vmcnt(0)
  s_mov_b64 exec, 1
  v_mov_b32 v6, s20
  buffer_store_dword v6, off, s[16:19], s44 sc1
  s_mov_b64 exec, -1
  s_mov_b32 s57, 0
AS_13:
  ds_read_b32 v1, v4
  s_add_u32 s57, s57, 1
  s_waitcnt lgkmcnt(0)
  v_cmp_gt_u32 vcc, -1, v1
  s_cbranch_vccz AS_13x
  s_cmp_lt_u32 s57, 320000
  s_cbranch_scc1 AS_13
AS_13x:
A_J:
  s_setprio 0
  s_mul_i32 s40, s23, 224
  s_mul_i32 s41, s54, 28
  s_add_u32 s40, s40, s41
  s_add_u32 s40, s40, 8206
  s_add_u32 s41, s40, 14
  s_add_u32 s42, s40, s36
  s_lshl_b32 s40, s40, 10
  s_lshl_b32 s41, s41, 10
  s_lshl_b32 s42, s42, 10
  s_lshl_b32 s43, s54, 14
  s_add_u32 s43, s43, 0
  v_add_u32 v5, s43, v3
  buffer_load_dwordx4 v[80:83], v3, s[16:19], s42 offen
  buffer_load_dwordx4 v[84:87], v2, s[16:19], s42 offen
  s_add_u32 s42, s42, 1024
  s_cmp_eq_u32 s42, s41
  s_cselect_b32 s42, s40, s42
  buffer_load_dwordx4 v[88:91], v3, s[16:19], s42 offen
  buffer_load_dwordx4 v[92:95], v2, s[16:19], s42 offen
  s_add_u32 s42, s42, 1024
  s_cmp_eq_u32 s42, s41
  s_cselect_b32 s42, s40, s42
  buffer_load_dwordx4 v[96:99], v3, s[16:19], s42 offen
  buffer_load_dwordx4 v[100:103], v2, s[16:19], s42 offen
  s_add_u32 s42, s42, 1024
  s_cmp_eq_u32 s42, s41
  s_cselect_b32 s42, s40, s42
  buffer_load_dwordx4 v[104:107], v3, s[16:19], s42 offen
  buffer_load_dwordx4 v[108:111], v2, s[16:19], s42 offen
  s_add_u32 s42, s42, 1024
  s_cmp_eq_u32 s42, s41
  s_cselect_b32 s42, s40, s42
  buffer_load_dwordx4 v[112:115], v3, s[16:19], s42 offen
  buffer_load_dwordx4 v[116:119], v2, s[16:19], s42 offen
  s_add_u32 s42, s42, 1024
  s_cmp_eq_u32 s42, s41
  s_cselect_b32 s42, s40, s42
  buffer_load_dwordx4 v[120:123], v3, s[16:19], s42 offen
  buffer_load_dwordx4 v[124:127], v2, s[16:19], s42 offen
  s_add_u32 s42, s42, 1024
  s_cmp_eq_u32 s42, s41
  s_cselect_b32 s42, s40, s42
  s_waitcnt vmcnt(12)
  s_mov_b64 exec, 1
  v_mov_b32 v6, s20
  buffer_store_dword v6, off, s[16:19], s44 sc1
  s_mov_b64 exec, -1
  s_waitcnt vmcnt(11)
  v_mfma_f32_32x32x16_bf16 v[16:31], v[224:227], v[80:83], 0
  v_mfma_f32_32x32x16_bf16 v[32:47], v[228:231], v[80:83], 0
  v_mfma_f32_32x32x16_bf16 v[48:63], v[224:227], v[84:87], 0
  v_mfma_f32_32x32x16_bf16 v[64:79], v[228:231], v[84:87], 0
  buffer_load_dwordx4 v[128:131], v3, s[16:19], s42 offen
  buffer_load_dwordx4 v[132:135], v2, s[16:19], s42 offen
  s_add_u32 s42, s42, 1024
  s_cmp_eq_u32 s42, s41
  s_cselect_b32 s42, s40, s42
  s_waitcnt vmcnt(11)
  v_mfma_f32_32x32x16_bf16 v[16:31], v[232:235], v[88:91], v[16:31]
  v_mfma_f32_32x32x16_bf16 v[32:47], v[236:239], v[88:91], v[32:47]
  v_mfma_f32_32x32x16_bf16 v[48:63], v[232:235], v[92:95], v[48:63]
  v_mfma_f32_32x32x16_bf16 v[64:79], v[236:239], v[92:95], v[64:79]
  buffer_load_dwordx4 v[136:139], v3, s[16:19], s42 offen
  buffer_load_dwordx4 v[140:143], v2, s[16:19], s42 offen
  s_add_u32 s42, s42, 1024
  s_cmp_eq_u32 s42, s41
  s_cselect_b32 s42, s40, s42
  s_waitcnt vmcnt(11)
  v_mfma_f32_32x32x16_bf16 v[16:31], v[240:243], v[96:99], v[16:31]
  v_mfma_f32_32x32x16_bf16 v[32:47], v[244:247], v[96:99], v[32:47]
  v_mfma_f32_32x32x16_bf16 v[48:63], v[240:243], v[100:103], v[48:63]
  v_mfma_f32_32x32x16_bf16 v[64:79], v[244:247], v[100:103], v[64:79]
  s_add_u32 m0, s43, 0
  s_nop 0
  buffer_load_dwordx4 v3, s[16:19], s42 offen lds
  s_add_u32 m0, s43, 1024
  s_nop 0
  buffer_load_dwordx4 v2, s[16:19], s42 offen lds
  s_add_u32 s42, s42, 1024
  s_cmp_eq_u32 s42, s41
  s_cselect_b32 s42, s40, s42
  s_waitcnt vmcnt(11)
  v_mfma_f32_32x32x16_bf16 v[16:31], v[248:251], v[104:107], v[16:31]
  v_mfma_f32_32x32x16_bf16 v[32:47], v[252:255], v[104:107], v[32:47]
  v_mfma_f32_32x32x16_bf16 v[48:63], v[248:251], v[108:111], v[48:63]
  v_mfma_f32_32x32x16_bf16 v[64:79], v[252:255], v[108:111], v[64:79]
  s_add_u32 m0, s43, 2048
  s_nop 0
  buffer_load_dwordx4 v3, s[16:19], s42 offen lds
  s_add_u32 m0, s43, 3072
  s_nop 0
  buffer_load_dwordx4 v2, s[16:19], s42 offen lds
  s_add_u32 s42, s42, 1024
  s_cmp_eq_u32 s42, s41
  s_cselect_b32 s42, s40, s42
  s_waitcnt vmcnt(11)
  v_mfma_f32_32x32x16_bf16 v[16:31], v[192:195], v[112:115], v[16:31]
  v_mfma_f32_32x32x16_bf16 v[32:47], v[196:199], v[112:115], v[32:47]
  v_mfma_f32_32x32x16_bf16 v[48:63], v[192:195], v[116:119], v[48:63]
  v_mfma_f32_32x32x16_bf16 v[64:79], v[196:199], v[116:119], v[64:79]
  s_add_u32 m0, s43, 4096
  s_nop 0
  buffer_load_dwordx4 v3, s[16:19], s42 offen lds
  s_add_u32 m0, s43, 5120
  s_nop 0
  buffer_load_dwordx4 v2, s[16:19], s42 offen lds
  s_add_u32 s42, s42, 1024
  s_cmp_eq_u32 s42, s41
  s_cselect_b32 s42, s40, s42
  s_waitcnt vmcnt(11)
  v_mfma_f32_32x32x16_bf16 v[16:31], v[200:203], v[120:123], v[16:31]
  v_mfma_f32_32x32x16_bf16 v[32:47], v[204:207], v[120:123], v[32:47]
  v_mfma_f32_32x32x16_bf16 v[48:63], v[200:203], v[124:127], v[48:63]
  v_mfma_f32_32x32x16_bf16 v[64:79], v[204:207], v[124:127], v[64:79]
  s_mov_b32 s24, s4
  s_and_b32 s25, s5, 0xffff
  s_mov_b32 s26, 1835008
  s_mov_b32 s27, 0x20000
  s_mov_b32 s28, s14
  s_and_b32 s29, s15, 0xffff
  s_mov_b32 s30, 1835008
  s_mov_b32 s31, 0x20000
  v_lshrrev_b32 v242, 3, v0
  v_and_b32 v243, 7, v0
  s_lshl_b32 s38, s3, 3
  s_lshl_b32 s39, s23, 6
  s_add_u32 s39, s39, s38
  s_mul_i32 s39, s39, 896
  s_lshl_b32 s47, s52, 7
  s_add_u32 s39, s39, s47
  v_mul_u32_u24 v236, 896, v242
  v_lshl_add_u32 v236, v243, 4, v236
  buffer_load_dwordx4 v[232:235], v236, s[24:27], s39 offen
  v_and_b32 v225, 31, v0
  v_lshrrev_b32 v224, 5, v0
  v_and_b32 v226, 1, v0
  v_xor_b32 v224, v224, v243
  v_lshl_or_b32 v224, v226, 3, v224
  v_lshlrev_b32 v224, 4, v224
  v_lshl_or_b32 v224, v225, 8, v224
  v_add_u32 v224, s43, v224
  v_xor_b32 v225, 32, v224
  v_xor_b32 v226, 64, v224
  v_xor_b32 v227, 96, v224
  v_xor_b32 v228, 128, v224
  v_xor_b32 v229, 160, v224
  v_xor_b32 v230, 192, v224
  v_xor_b32 v231, 224, v224
  v_and_b32 v237, 1, v242
  v_lshl_or_b32 v237, v237, 3, v242
  v_xor_b32 v237, v237, v243
  v_lshlrev_b32 v237, 4, v237
  v_add_u32 v242, s38, v242
  v_lshl_or_b32 v237, v242, 8, v237
  v_xor_b32 v238, 128, v237
  v_add_u32 v239, 98304, v237
  v_add_u32 v240, 98304, v238
  v_mul_u32_u24 v241, 1040, v243
  v_lshl_add_u32 v241, v242, 1, v241
  v_add_u32 v241, 82448, v241
  v_mov_b32 v242, 0xbfb8aa3b
  v_mov_b32 v243, 0xbfb8aa3b
  v_mov_b32 v244, 0
  v_mov_b32 v245, 0
  v_mov_b32 v246, 0
  v_mov_b32 v247, 0
  v_mov_b32 v248, 0
  v_mov_b32 v249, 0
  v_mov_b32 v250, 0
  v_mov_b32 v251, 0
  s_add_u32 m0, s43, 6144
  s_nop 0
  buffer_load_dwordx4 v3, s[16:19], s42 offen lds
  s_add_u32 m0, s43, 7168
  s_nop 0
  buffer_load_dwordx4 v2, s[16:19], s42 offen lds
  s_add_u32 s42, s42, 1024
  s_cmp_eq_u32 s42, s41
  s_cselect_b32 s42, s40, s42
  s_waitcnt vmcnt(11)
  v_mfma_f32_32x32x16_bf16 v[16:31], v[208:211], v[128:131], v[16:31]
  v_mfma_f32_32x32x16_bf16 v[32:47], v[212:215], v[128:131], v[32:47]
  v_mfma_f32_32x32x16_bf16 v[48:63], v[208:211], v[132:135], v[48:63]
  v_mfma_f32_32x32x16_bf16 v[64:79], v[212:215], v[132:135], v[64:79]
  s_add_u32 m0, s43, 8192
  s_nop 0
  buffer_load_dwordx4 v3, s[16:19], s42 offen lds
  s_add_u32 m0, s43, 9216
  s_nop 0
  buffer_load_dwordx4 v2, s[16:19], s42 offen lds
  s_add_u32 s42, s42, 1024
  s_cmp_eq_u32 s42, s41
  s_cselect_b32 s42, s40, s42
  s_waitcnt vmcnt(11)
  s_waitcnt vmcnt(9)
  ds_read_b128 v[80:83], v5 offset:0
  ds_read_b128 v[84:87], v5 offset:1024
  v_mfma_f32_32x32x16_bf16 v[16:31], v[216:219], v[136:139], v[16:31]
  v_mfma_f32_32x32x16_bf16 v[32:47], v[220:223], v[136:139], v[32:47]
  v_mfma_f32_32x32x16_bf16 v[48:63], v[216:219], v[140:143], v[48:63]
  v_mfma_f32_32x32x16_bf16 v[64:79], v[220:223], v[140:143], v[64:79]
  s_add_u32 m0, s43, 10240
  s_nop 0
  buffer_load_dwordx4 v3, s[16:19], s42 offen lds
  s_add_u32 m0, s43, 11264
  s_nop 0
  buffer_load_dwordx4 v2, s[16:19], s42 offen lds
  s_waitcnt lgkmcnt(0)
  s_waitcnt vmcnt(9)
  ds_read_b128 v[88:91], v5 offset:2048
  ds_read_b128 v[92:95], v5 offset:3072
  v_mfma_f32_32x32x16_bf16 v[16:31], v[184:187], v[80:83], v[16:31]
  v_mfma_f32_32x32x16_bf16 v[32:47], v[188:191], v[80:83], v[32:47]
  v_mfma_f32_32x32x16_bf16 v[48:63], v[184:187], v[84:87], v[48:63]
  v_mfma_f32_32x32x16_bf16 v[64:79], v[188:191], v[84:87], v[64:79]
  s_waitcnt lgkmcnt(0)
  s_waitcnt vmcnt(7)
  ds_read_b128 v[96:99], v5 offset:4096
  ds_read_b128 v[100:103], v5 offset:5120
  v_mfma_f32_32x32x16_bf16 v[16:31], v[176:179], v[88:91], v[16:31]
  v_mfma_f32_32x32x16_bf16 v[32:47], v[180:183], v[88:91], v[32:47]
  v_mfma_f32_32x32x16_bf16 v[48:63], v[176:179], v[92:95], v[48:63]
  v_mfma_f32_32x32x16_bf16 v[64:79], v[180:183], v[92:95], v[64:79]
  s_waitcnt lgkmcnt(0)
  s_waitcnt vmcnt(4)
  ds_read_b128 v[104:107], v5 offset:6144
  ds_read_b128 v[108:111], v5 offset:7168
  v_mfma_f32_32x32x16_bf16 v[16:31], v[168:171], v[96:99], v[16:31]
  v_mfma_f32_32x32x16_bf16 v[32:47], v[172:175], v[96:99], v[32:47]
  v_mfma_f32_32x32x16_bf16 v[48:63], v[168:171], v[100:103], v[48:63]
  v_mfma_f32_32x32x16_bf16 v[64:79], v[172:175], v[100:103], v[64:79]
  s_waitcnt lgkmcnt(0)
  s_waitcnt vmcnt(2)
  ds_read_b128 v[112:115], v5 offset:8192
  ds_read_b128 v[116:119], v5 offset:9216
  v_mfma_f32_32x32x16_bf16 v[16:31], v[160:163], v[104:107], v[16:31]
  v_mfma_f32_32x32x16_bf16 v[32:47], v[164:167], v[104:107], v[32:47]
  v_mfma_f32_32x32x16_bf16 v[48:63], v[160:163], v[108:111], v[48:63]
  v_mfma_f32_32x32x16_bf16 v[64:79], v[164:167], v[108:111], v[64:79]
  s_waitcnt lgkmcnt(0)
  s_waitcnt vmcnt(0)
  ds_read_b128 v[120:123], v5 offset:10240
  ds_read_b128 v[124:127], v5 offset:11264
  v_mfma_f32_32x32x16_bf16 v[16:31], v[152:155], v[112:115], v[16:31]
  v_mfma_f32_32x32x16_bf16 v[32:47], v[156:159], v[112:115], v[32:47]
  v_mfma_f32_32x32x16_bf16 v[48:63], v[152:155], v[116:119], v[48:63]
  v_mfma_f32_32x32x16_bf16 v[64:79], v[156:159], v[116:119], v[64:79]
  s_waitcnt lgkmcnt(0)
  v_mfma_f32_32x32x16_bf16 v[16:31], v[144:147], v[120:123], v[16:31]
  v_mfma_f32_32x32x16_bf16 v[32:47], v[148:151], v[120:123], v[32:47]
  v_mfma_f32_32x32x16_bf16 v[48:63], v[144:147], v[124:127], v[48:63]
  v_mfma_f32_32x32x16_bf16 v[64:79], v[148:151], v[124:127], v[64:79]
  s_nop 8
  ds_write_b128 v224, v[16:19] offset:0
  ds_write_b128 v225, v[20:23] offset:0
  ds_write_b128 v226, v[24:27] offset:0
  ds_write_b128 v227, v[28:31] offset:0
  ds_write_b128 v228, v[32:35] offset:0
  ds_write_b128 v229, v[36:39] offset:0
  ds_write_b128 v230, v[40:43] offset:0
  ds_write_b128 v231, v[44:47] offset:0
  ds_write_b128 v224, v[48:51] offset:8192
  ds_write_b128 v225, v[52:55] offset:8192
  ds_write_b128 v226, v[56:59] offset:8192
  ds_write_b128 v227, v[60:63] offset:8192
  ds_write_b128 v228, v[64:67] offset:8192
  ds_write_b128 v229, v[68:71] offset:8192
  ds_write_b128 v230, v[72:75] offset:8192
  ds_write_b128 v231, v[76:79] offset:8192
FINAL:
  v_lshlrev_b32 v160, 16, v232
  v_and_b32 v161, 0xffff0000, v232
  v_lshlrev_b32 v162, 16, v233
  v_and_b32 v163, 0xffff0000, v233
  v_lshlrev_b32 v164, 16, v234
  v_and_b32 v165, 0xffff0000, v234
  v_lshlrev_b32 v166, 16, v235
  v_and_b32 v167, 0xffff0000, v235
  s_waitcnt lgkmcnt(0)
  s_barrier
  ds_read_b128 v[96:99], v237 offset:0
  ds_read_b128 v[100:103], v238 offset:0
  ds_read_b128 v[104:107], v237 offset:16384
  ds_read_b128 v[108:111], v238 offset:16384
  ds_read_b128 v[112:115], v237 offset:32768
  ds_read_b128 v[116:119], v238 offset:32768
  ds_read_b128 v[120:123], v237 offset:49152
  ds_read_b128 v[124:127], v238 offset:49152
  ds_read_b128 v[128:131], v239 offset:0
  ds_read_b128 v[132:135], v240 offset:0
  s_waitcnt lgkmcnt(6)
  v_pk_add_f32 v[96:97], v[96:97], v[104:105]
  v_pk_add_f32 v[98:99], v[98:99], v[106:107]
  v_pk_add_f32 v[100:101], v[100:101], v[108:109]
  v_pk_add_f32 v[102:103], v[102:103], v[110:111]
  ds_read_u16_d16_hi v244, v241 offset:0
  ds_read_u16_d16_hi v245, v241 offset:128
  ds_read_u16_d16_hi v246, v241 offset:256
  ds_read_u16_d16_hi v247, v241 offset:384
  ds_read_u16_d16_hi v248, v241 offset:512
  ds_read_u16_d16_hi v249, v241 offset:640
  ds_read_u16_d16_hi v250, v241 offset:768
  ds_read_u16_d16_hi v251, v241 offset:896
  s_waitcnt lgkmcnt(12)
  v_pk_add_f32 v[96:97], v[96:97], v[112:113]
  v_pk_add_f32 v[98:99], v[98:99], v[114:115]
  v_pk_add_f32 v[100:101], v[100:101], v[116:117]
  v_pk_add_f32 v[102:103], v[102:103], v[118:119]
  s_waitcnt lgkmcnt(10)
  v_pk_add_f32 v[96:97], v[96:97], v[120:121]
  v_pk_add_f32 v[98:99], v[98:99], v[122:123]
  v_pk_add_f32 v[100:101], v[100:101], v[124:125]
  v_pk_add_f32 v[102:103], v[102:103], v[126:127]
  s_waitcnt lgkmcnt(8)
  v_pk_add_f32 v[96:97], v[96:97], v[128:129]
  v_pk_add_f32 v[98:99], v[98:99], v[130:131]
  v_pk_add_f32 v[100:101], v[100:101], v[132:133]
  v_pk_add_f32 v[102:103], v[102:103], v[134:135]
  v_cvt_pk_bf16_f32 v24, v96, v100
  v_cvt_pk_bf16_f32 v26, v97, v101
  v_cvt_pk_bf16_f32 v28, v98, v102
  v_cvt_pk_bf16_f32 v30, v99, v103
  v_lshlrev_b32 v96, 16, v24
  v_and_b32 v97, 0xffff0000, v24
  v_lshlrev_b32 v98, 16, v26
  v_and_b32 v99, 0xffff0000, v26
  v_lshlrev_b32 v100, 16, v28
  v_and_b32 v101, 0xffff0000, v28
  v_lshlrev_b32 v102, 16, v30
  v_and_b32 v103, 0xffff0000, v30
  v_pk_mul_f32 v[24:25], v[96:97], v[242:243]
  v_pk_mul_f32 v[26:27], v[98:99], v[242:243]
  v_pk_mul_f32 v[28:29], v[100:101], v[242:243]
  v_pk_mul_f32 v[30:31], v[102:103], v[242:243]
  v_exp_f32 v24, v24
  v_exp_f32 v25, v25
  v_exp_f32 v26, v26
  v_exp_f32 v27, v27
  v_exp_f32 v28, v28
  v_exp_f32 v29, v29
  v_exp_f32 v30, v30
  v_exp_f32 v31, v31
  v_pk_add_f32 v[24:25], v[24:25], 1.0 op_sel_hi:[1,0]
  v_pk_add_f32 v[26:27], v[26:27], 1.0 op_sel_hi:[1,0]
  v_pk_add_f32 v[28:29], v[28:29], 1.0 op_sel_hi:[1,0]
  v_pk_add_f32 v[30:31], v[30:31], 1.0 op_sel_hi:[1,0]
  v_rcp_f32 v24, v24
  v_rcp_f32 v25, v25
  v_rcp_f32 v26, v26
  v_rcp_f32 v27, v27
  v_rcp_f32 v28, v28
  v_rcp_f32 v29, v29
  v_rcp_f32 v30, v30
  v_rcp_f32 v31, v31
  v_pk_mul_f32 v[96:97], v[96:97], v[24:25]
  v_pk_mul_f32 v[98:99], v[98:99], v[26:27]
  v_pk_mul_f32 v[100:101], v[100:101], v[28:29]
  v_pk_mul_f32 v[102:103], v[102:103], v[30:31]
  v_cvt_pk_bf16_f32 v24, v96, v97
  v_cvt_pk_bf16_f32 v26, v98, v99
  v_cvt_pk_bf16_f32 v28, v100, v101
  v_cvt_pk_bf16_f32 v30, v102, v103
  v_lshlrev_b32 v96, 16, v24
  v_and_b32 v97, 0xffff0000, v24
  v_lshlrev_b32 v98, 16, v26
  v_and_b32 v99, 0xffff0000, v26
  v_lshlrev_b32 v100, 16, v28
  v_and_b32 v101, 0xffff0000, v28
  v_lshlrev_b32 v102, 16, v30
  v_and_b32 v103, 0xffff0000, v30
  s_waitcnt lgkmcnt(0)
  v_pk_mul_f32 v[96:97], v[96:97], v[244:245]
  v_pk_mul_f32 v[98:99], v[98:99], v[246:247]
  v_pk_mul_f32 v[100:101], v[100:101], v[248:249]
  v_pk_mul_f32 v[102:103], v[102:103], v[250:251]
  v_cvt_pk_bf16_f32 v24, v96, v97
  v_cvt_pk_bf16_f32 v26, v98, v99
  v_cvt_pk_bf16_f32 v28, v100, v101
  v_cvt_pk_bf16_f32 v30, v102, v103
  v_lshlrev_b32 v96, 16, v24
  v_and_b32 v97, 0xffff0000, v24
  v_lshlrev_b32 v98, 16, v26
  v_and_b32 v99, 0xffff0000, v26
  v_lshlrev_b32 v100, 16, v28
  v_and_b32 v101, 0xffff0000, v28
  v_lshlrev_b32 v102, 16, v30
  v_and_b32 v103, 0xffff0000, v30
  v_pk_add_f32 v[96:97], v[96:97], v[160:161]
  v_pk_add_f32 v[98:99], v[98:99], v[162:163]
  v_pk_add_f32 v[100:101], v[100:101], v[164:165]
  v_pk_add_f32 v[102:103], v[102:103], v[166:167]
  v_cvt_pk_bf16_f32 v24, v96, v97
  v_cvt_pk_bf16_f32 v25, v98, v99
  v_cvt_pk_bf16_f32 v26, v100, v101
  v_cvt_pk_bf16_f32 v27, v102, v103
  buffer_store_dwordx4 v[24:27], v236, s[28:31], s39 offen
KEND:
  s_endpgm
GW:
  s_and_b32 s39, s3, 1
  s_add_u32 m0, s96, 0
  s_nop 0
  buffer_load_dwordx4 v112, s[24:27], s55 offen lds
  s_add_u32 m0, s96, 1024
  s_nop 0
  buffer_load_dwordx4 v113, s[24:27], s55 offen lds
  s_add_u32 s58, s55, 57344
  s_add_u32 m0, s96, 8192
  s_nop 0
  buffer_load_dwordx4 v112, s[24:27], s58 offen lds
  s_add_u32 m0, s96, 9216
  s_nop 0
  buffer_load_dwordx4 v113, s[24:27], s58 offen lds
  s_add_u32 s55, s55, 128
  s_cmp_eq_u32 s55, s98
  s_cselect_b32 s57, 896, 0
  s_sub_u32 s55, s55, s57
  v_and_b32 v4, 31, v0
  v_lshrrev_b32 v7, 5, v0
  v_bfe_u32 v6, v0, 1, 3
  v_xor_b32 v5, v7, v6
  s_lshl_b32 s40, s39, 13
  s_add_u32 s40, s40, 0
  v_lshl_add_u32 v10, v4, 7, s40
  v_lshl_add_u32 v8, v5, 4, v10
  v_xor_b32 v9, 32, v8
  v_xor_b32 v10, 64, v8
  v_xor_b32 v11, 96, v8
  v_bfe_u32 v6, v0, 2, 2
  v_lshl_add_u32 v5, v7, 3, v6
  v_lshlrev_b32 v5, 8, v5
  v_bfe_u32 v3, v0, 4, 1
  v_lshl_add_u32 v5, v3, 5, v5
  v_and_b32 v3, 3, v0
  v_lshl_add_u32 v5, v3, 3, v5
  v_add_u32 v5, 98304, v5
  s_and_b32 s40, s3, 2
  v_xor_b32 v6, s40, v6
  v_lshl_add_u32 v12, v6, 6, v5
  v_xor_b32 v13, 64, v12
  v_add_u32 v14, 32768, v12
  v_add_u32 v15, 32768, v13
  s_lshl_b32 s40, s40, 8
  s_add_u32 s41, s40, 93568
  v_lshl_add_u32 v204, v4, 3, s41
  s_lshl_b32 s41, s39, 10
  s_add_u32 s40, s40, s41
  s_add_u32 s41, s41, 95616
  v_lshl_add_u32 v205, v4, 4, s41
  v_mov_b32 v200, 0x3f803f80
  v_mov_b32 v201, v200
  v_mov_b32 v202, v200
  v_mov_b32 v203, v200
  v_lshlrev_b32 v2, 4, v0
  v_add_u32 v1, 114688, v2
  v_lshlrev_b32 v6, 3, v0
  v_cmp_gt_u32 vcc, 32, v0
  s_and_b32 s43, s59, 3
  s_mov_b32 s42, s59
  s_cmp_ge_u32 s42, 14
  s_cselect_b32 s43, 32, s43
  s_lshl_b32 s45, s22, 4
  s_add_u32 s42, s42, s45
  s_lshl_b32 s42, s42, 11
  s_add_u32 s42, s42, s40
  s_add_u32 s42, s42, 524288
  s_lshl_b32 s43, s43, 1
  s_add_u32 s43, s43, s39
  s_lshl_b32 s45, s53, 7
  s_add_u32 s45, s45, 393216
  s_lshl_b32 s37, s21, 1
  s_add_u32 s37, s37, s39
  s_mul_i32 s44, s37, 28
  s_mul_i32 s37, s37, 224
  s_lshl_b32 s38, s22, 1
  s_lshr_b32 s40, s3, 1
  s_add_u32 s38, s38, s40
  s_add_u32 s44, s44, s38
  s_lshl_b32 s44, s44, 7
  s_add_u32 s44, s44, 65536
  s_lshl_b32 s38, s38, 2
  s_add_u32 s37, s37, s38
  s_lshl_b32 s37, s37, 10
  s_add_u32 s37, s37, 8388608
  s_add_u32 s38, s37, 114688
  s_mul_i32 s40, s23, 28
  s_mul_i32 s41, s54, 7
  s_add_u32 s40, s40, s41
  s_lshl_b32 s40, s40, 7
  s_add_u32 s40, s40, 65536
  v_min_u32 v3, 6, v0
  v_lshl_add_u32 v4, v3, 7, s40
  s_lshl_b32 s40, s3, 2
  s_add_u32 s40, s40, 97664
  v_mov_b32 v7, s40
  s_mul_i32 s46, s54, 16368
  s_mov_b32 m0, s46
  s_waitcnt lgkmcnt(0)
  s_lshr_b32 s57, s54, 1
  s_lshl_b32 s57, s57, 4
  s_lshr_b32 s100, s100, s57
  s_lshl_b32 s100, s100, 16
  s_lshr_b32 s101, s101, s57
  v_mov_b32 v126, 0x3fb8aa3b
  v_mul_f32 v126, s100, v126
  v_exp_f32 v126, v126
  s_nop 0
  v_cvt_pk_bf16_f32 v126, v126, v126
  v_and_b32 v126, 0xffff0000, v126
  s_mul_i32 s20, s20, 0x9e3779b1
  s_add_u32 s20, s20, 0x7f4a7c15
  v_and_b32 v214, 3, v0
  v_lshlrev_b32 v214, 2, v214
  v_add_u32 v214, 97680, v214
  s_mul_i32 s36, s52, 32
  s_lshr_b32 s36, s36, 4
  s_and_b32 s58, s23, 3
  s_mul_i32 s58, s58, 3
  s_add_u32 s36, s36, s58
  s_cmp_ge_u32 s36, 14
  s_cselect_b32 s58, 14, 0
  s_sub_u32 s36, s36, s58
  s_mul_i32 s59, s52, 112
  s_mul_i32 s60, s54, 28
  s_add_u32 s59, s59, s60
  s_add_u32 s59, s59, 2048
  s_add_u32 s60, s59, 14
  s_add_u32 s61, s59, s36
  s_lshl_b32 s59, s59, 11
  s_lshl_b32 s60, s60, 11
  s_lshl_b32 s61, s61, 11
  s_add_u32 s55, s55, 128
  s_cmp_eq_u32 s55, s98
  s_cselect_b32 s57, 896, 0
  s_sub_u32 s55, s55, s57
  s_add_u32 s56, s56, 114688
  s_cmp_eq_u32 s56, s99
  s_cselect_b32 s57, 1605632, 0
  s_sub_u32 s56, s56, s57
  s_add_u32 s56, s56, 114688
  s_cmp_eq_u32 s56, s99
  s_cselect_b32 s57, 1605632, 0
  s_sub_u32 s56, s56, s57
  s_add_u32 s56, s56, 114688
  s_cmp_eq_u32 s56, s99
  s_cselect_b32 s57, 1605632, 0
  s_sub_u32 s56, s56, s57
  s_add_u32 s56, s56, 114688
  s_cmp_eq_u32 s56, s99
  s_cselect_b32 s57, 1605632, 0
  s_sub_u32 s56, s56, s57
  v_mov_b32 v210, v112
  v_mov_b32 v211, v113
  v_mov_b32 v212, v114
  v_mov_b32 v213, v115
  s_waitcnt vmcnt(4)
  v_lshlrev_b32 v128, 16, v120
  v_and_b32 v129, 0xffff0000, v120
  v_lshlrev_b32 v130, 16, v121
  v_and_b32 v131, 0xffff0000, v121
  v_pk_mul_f32 v[128:129], v[128:129], v[126:127] op_sel_hi:[1,0]
  v_pk_mul_f32 v[130:131], v[130:131], v[126:127] op_sel_hi:[1,0]
  v_mul_f32 v134, 0x3fa2f983, v130
  v_mul_f32 v135, 0x3fa2f983, v131
  v_mul_f32 v132, 0x4138aa3b, v128
  v_mul_f32 v133, 0x4138aa3b, v129
  v_fract_f32 v134, v134
  v_fract_f32 v135, v135
  v_exp_f32 v132, v132
  v_exp_f32 v133, v133
  v_cos_f32 v136, v134
  v_cos_f32 v137, v135
  v_sin_f32 v138, v134
  v_sin_f32 v139, v135
  v_pk_mul_f32 v[136:137], v[136:137], v[132:133]
  v_pk_mul_f32 v[138:139], v[138:139], v[132:133]
  v_pk_mul_f32 v[140:141], v[136:137], v[136:137]
  v_cvt_pk_bf16_f32 v184, v136, v137
  v_pk_mul_f32 v[142:143], v[136:137], v[138:139]
  v_cvt_pk_bf16_f32 v185, v138, v139
  v_pk_fma_f32 v[140:141], v[138:139], v[138:139], v[140:141] neg_lo:[1,0,0] neg_hi:[1,0,0]
  ds_write_addtid_b32 v184 offset:32768
  v_pk_fma_f32 v[142:143], v[138:139], v[136:137], v[142:143]
  ds_write_addtid_b32 v185 offset:33024
  v_pk_mul_f32 v[148:149], v[140:141], v[140:141]
  v_pk_mul_f32 v[144:145], v[140:141], v[136:137]
  v_cvt_pk_bf16_f32 v186, v140, v141
  v_pk_mul_f32 v[150:151], v[140:141], v[142:143]
  v_pk_mul_f32 v[146:147], v[140:141], v[138:139]
  v_cvt_pk_bf16_f32 v187, v142, v143
  v_pk_fma_f32 v[148:149], v[142:143], v[142:143], v[148:149] neg_lo:[1,0,0] neg_hi:[1,0,0]
  v_pk_fma_f32 v[144:145], v[142:143], v[138:139], v[144:145] neg_lo:[1,0,0] neg_hi:[1,0,0]
  ds_write_addtid_b32 v186 offset:33296
  v_pk_fma_f32 v[150:151], v[142:143], v[140:141], v[150:151]
  v_pk_fma_f32 v[146:147], v[142:143], v[136:137], v[146:147]
  ds_write_addtid_b32 v187 offset:33552
  v_pk_mul_f32 v[152:153], v[136:137], v[148:149]
  v_pk_mul_f32 v[160:161], v[140:141], v[148:149]
  v_cvt_pk_bf16_f32 v188, v144, v145
  v_cvt_pk_bf16_f32 v190, v148, v149
  v_pk_mul_f32 v[154:155], v[136:137], v[150:151]
  v_pk_mul_f32 v[162:163], v[140:141], v[150:151]
  v_cvt_pk_bf16_f32 v189, v146, v147
  v_cvt_pk_bf16_f32 v191, v150, v151
  v_pk_fma_f32 v[152:153], v[138:139], v[150:151], v[152:153] neg_lo:[1,0,0] neg_hi:[1,0,0]
  v_pk_fma_f32 v[160:161], v[142:143], v[150:151], v[160:161] neg_lo:[1,0,0] neg_hi:[1,0,0]
  ds_write_addtid_b32 v188 offset:33824
  ds_write_addtid_b32 v190 offset:34352
  v_pk_fma_f32 v[154:155], v[138:139], v[148:149], v[154:155]
  v_pk_fma_f32 v[162:163], v[142:143], v[148:149], v[162:163]
  ds_write_addtid_b32 v189 offset:34080
  ds_write_addtid_b32 v191 offset:34608
  v_cvt_pk_bf16_f32 v184, v152, v153
  v_cvt_pk_bf16_f32 v186, v160, v161
  v_pk_mul_f32 v[168:169], v[144:145], v[148:149]
  v_pk_mul_f32 v[176:177], v[148:149], v[148:149]
  v_cvt_pk_bf16_f32 v185, v154, v155
  v_cvt_pk_bf16_f32 v187, v162, v163
  v_pk_mul_f32 v[170:171], v[144:145], v[150:151]
  v_pk_mul_f32 v[178:179], v[148:149], v[150:151]
  ds_write_addtid_b32 v184 offset:34880
  ds_write_addtid_b32 v186 offset:35408
  v_pk_fma_f32 v[168:169], v[146:147], v[150:151], v[168:169] neg_lo:[1,0,0] neg_hi:[1,0,0]
  v_pk_fma_f32 v[176:177], v[150:151], v[150:151], v[176:177] neg_lo:[1,0,0] neg_hi:[1,0,0]
  ds_write_addtid_b32 v185 offset:35136
  ds_write_addtid_b32 v187 offset:35664
  v_pk_fma_f32 v[170:171], v[146:147], v[148:149], v[170:171]
  v_pk_fma_f32 v[178:179], v[150:151], v[148:149], v[178:179]
  v_pk_mul_f32 v[156:157], v[152:153], v[148:149]
  v_pk_mul_f32 v[164:165], v[160:161], v[148:149]
  v_cvt_pk_bf16_f32 v188, v168, v169
  v_cvt_pk_bf16_f32 v190, v176, v177
  v_pk_mul_f32 v[158:159], v[152:153], v[150:151]
  v_pk_mul_f32 v[166:167], v[160:161], v[150:151]
  v_cvt_pk_bf16_f32 v189, v170, v171
  v_cvt_pk_bf16_f32 v191, v178, v179
  v_pk_fma_f32 v[156:157], v[154:155], v[150:151], v[156:157] neg_lo:[1,0,0] neg_hi:[1,0,0]
  v_pk_fma_f32 v[164:165], v[162:163], v[150:151], v[164:165] neg_lo:[1,0,0] neg_hi:[1,0,0]
  ds_write_addtid_b32 v188 offset:35936
  ds_write_addtid_b32 v190 offset:36464
  v_pk_fma_f32 v[158:159], v[154:155], v[148:149], v[158:159]
  v_pk_fma_f32 v[166:167], v[162:163], v[148:149], v[166:167]
  ds_write_addtid_b32 v189 offset:36192
  ds_write_addtid_b32 v191 offset:36720
  v_cvt_pk_bf16_f32 v184, v156, v157
  v_cvt_pk_bf16_f32 v186, v164, v165
  v_pk_mul_f32 v[172:173], v[168:169], v[148:149]
  v_pk_mul_f32 v[180:181], v[176:177], v[148:149]
  v_cvt_pk_bf16_f32 v185, v158, v159
  v_cvt_pk_bf16_f32 v187, v166, v167
  v_pk_mul_f32 v[174:175], v[168:169], v[150:151]
  v_pk_mul_f32 v[182:183], v[176:177], v[150:151]
  ds_write_addtid_b32 v184 offset:36992
  ds_write_addtid_b32 v186 offset:37520
  v_pk_fma_f32 v[172:173], v[170:171], v[150:151], v[172:173] neg_lo:[1,0,0] neg_hi:[1,0,0]
  v_pk_fma_f32 v[180:181], v[178:179], v[150:151], v[180:181] neg_lo:[1,0,0] neg_hi:[1,0,0]
  ds_write_addtid_b32 v185 offset:37248
  ds_write_addtid_b32 v187 offset:37776
  v_pk_fma_f32 v[174:175], v[170:171], v[148:149], v[174:175]
  v_pk_fma_f32 v[182:183], v[178:179], v[148:149], v[182:183]
  v_pk_mul_f32 v[152:153], v[156:157], v[148:149]
  v_pk_mul_f32 v[160:161], v[164:165], v[148:149]
  v_cvt_pk_bf16_f32 v188, v172, v173
  v_cvt_pk_bf16_f32 v190, v180, v181
  v_pk_mul_f32 v[154:155], v[156:157], v[150:151]
  v_pk_mul_f32 v[162:163], v[164:165], v[150:151]
  v_cvt_pk_bf16_f32 v189, v174, v175
  v_cvt_pk_bf16_f32 v191, v182, v183
  v_pk_fma_f32 v[152:153], v[158:159], v[150:151], v[152:153] neg_lo:[1,0,0] neg_hi:[1,0,0]
  v_pk_fma_f32 v[160:161], v[166:167], v[150:151], v[160:161] neg_lo:[1,0,0] neg_hi:[1,0,0]
  ds_write_addtid_b32 v188 offset:38048
  ds_write_addtid_b32 v190 offset:38576
  v_pk_fma_f32 v[154:155], v[158:159], v[148:149], v[154:155]
  v_pk_fma_f32 v[162:163], v[166:167], v[148:149], v[162:163]
  ds_write_addtid_b32 v189 offset:38304
  ds_write_addtid_b32 v191 offset:38832
  v_cvt_pk_bf16_f32 v184, v152, v153
  v_cvt_pk_bf16_f32 v186, v160, v161
  v_pk_mul_f32 v[168:169], v[172:173], v[148:149]
  v_pk_mul_f32 v[176:177], v[180:181], v[148:149]
  v_cvt_pk_bf16_f32 v185, v154, v155
  v_cvt_pk_bf16_f32 v187, v162, v163
  v_pk_mul_f32 v[170:171], v[172:173], v[150:151]
  v_pk_mul_f32 v[178:179], v[180:181], v[150:151]
  ds_write_addtid_b32 v184 offset:39104
  ds_write_addtid_b32 v186 offset:39632
  v_pk_fma_f32 v[168:169], v[174:175], v[150:151], v[168:169] neg_lo:[1,0,0] neg_hi:[1,0,0]
  v_pk_fma_f32 v[176:177], v[182:183], v[150:151], v[176:177] neg_lo:[1,0,0] neg_hi:[1,0,0]
  ds_write_addtid_b32 v185 offset:39360
  ds_write_addtid_b32 v187 offset:39888
  v_pk_fma_f32 v[170:171], v[174:175], v[148:149], v[170:171]
  v_pk_fma_f32 v[178:179], v[182:183], v[148:149], v[178:179]
  v_pk_mul_f32 v[156:157], v[152:153], v[148:149]
  v_pk_mul_f32 v[164:165], v[160:161], v[148:149]
  v_cvt_pk_bf16_f32 v188, v168, v169
  v_cvt_pk_bf16_f32 v190, v176, v177
  v_pk_mul_f32 v[158:159], v[152:153], v[150:151]
  v_pk_mul_f32 v[166:167], v[160:161], v[150:151]
  v_cvt_pk_bf16_f32 v189, v170, v171
  v_cvt_pk_bf16_f32 v191, v178, v179
  v_pk_fma_f32 v[156:157], v[154:155], v[150:151], v[156:157] neg_lo:[1,0,0] neg_hi:[1,0,0]
  v_pk_fma_f32 v[164:165], v[162:163], v[150:151], v[164:165] neg_lo:[1,0,0] neg_hi:[1,0,0]
  ds_write_addtid_b32 v188 offset:40160
  ds_write_addtid_b32 v190 offset:40688
  v_pk_fma_f32 v[158:159], v[154:155], v[148:149], v[158:159]
  v_pk_fma_f32 v[166:167], v[162:163], v[148:149], v[166:167]
  ds_write_addtid_b32 v189 offset:40416
  ds_write_addtid_b32 v191 offset:40944
  v_cvt_pk_bf16_f32 v184, v156, v157
  v_cvt_pk_bf16_f32 v186, v164, v165
  v_pk_mul_f32 v[172:173], v[168:169], v[148:149]
  v_pk_mul_f32 v[180:181], v[176:177], v[148:149]
  v_cvt_pk_bf16_f32 v185, v158, v159
  v_cvt_pk_bf16_f32 v187, v166, v167
  v_pk_mul_f32 v[174:175], v[168:169], v[150:151]
  v_pk_mul_f32 v[182:183], v[176:177], v[150:151]
  ds_write_addtid_b32 v184 offset:41216
  ds_write_addtid_b32 v186 offset:41744
  v_pk_fma_f32 v[172:173], v[170:171], v[150:151], v[172:173] neg_lo:[1,0,0] neg_hi:[1,0,0]
  v_pk_fma_f32 v[180:181], v[178:179], v[150:151], v[180:181] neg_lo:[1,0,0] neg_hi:[1,0,0]
  ds_write_addtid_b32 v185 offset:41472
  ds_write_addtid_b32 v187 offset:42000
  v_pk_fma_f32 v[174:175], v[170:171], v[148:149], v[174:175]
  v_pk_fma_f32 v[182:183], v[178:179], v[148:149], v[182:183]
  v_pk_mul_f32 v[152:153], v[156:157], v[148:149]
  v_pk_mul_f32 v[160:161], v[164:165], v[148:149]
  v_cvt_pk_bf16_f32 v188, v172, v173
  v_cvt_pk_bf16_f32 v190, v180, v181
  v_pk_mul_f32 v[154:155], v[156:157], v[150:151]
  v_pk_mul_f32 v[162:163], v[164:165], v[150:151]
  v_cvt_pk_bf16_f32 v189, v174, v175
  v_cvt_pk_bf16_f32 v191, v182, v183
  v_pk_fma_f32 v[152:153], v[158:159], v[150:151], v[152:153] neg_lo:[1,0,0] neg_hi:[1,0,0]
  v_pk_fma_f32 v[160:161], v[166:167], v[150:151], v[160:161] neg_lo:[1,0,0] neg_hi:[1,0,0]
  ds_write_addtid_b32 v188 offset:42272
  ds_write_addtid_b32 v190 offset:42800
  v_pk_fma_f32 v[154:155], v[158:159], v[148:149], v[154:155]
  v_pk_fma_f32 v[162:163], v[166:167], v[148:149], v[162:163]
  ds_write_addtid_b32 v189 offset:42528
  ds_write_addtid_b32 v191 offset:43056
  v_cvt_pk_bf16_f32 v184, v152, v153
  v_cvt_pk_bf16_f32 v186, v160, v161
  v_pk_mul_f32 v[168:169], v[172:173], v[148:149]
  v_pk_mul_f32 v[176:177], v[180:181], v[148:149]
  v_cvt_pk_bf16_f32 v185, v154, v155
  v_cvt_pk_bf16_f32 v187, v162, v163
  v_pk_mul_f32 v[170:171], v[172:173], v[150:151]
  v_pk_mul_f32 v[178:179], v[180:181], v[150:151]
  ds_write_addtid_b32 v184 offset:43328
  ds_write_addtid_b32 v186 offset:43856
  v_pk_fma_f32 v[168:169], v[174:175], v[150:151], v[168:169] neg_lo:[1,0,0] neg_hi:[1,0,0]
  v_pk_fma_f32 v[176:177], v[182:183], v[150:151], v[176:177] neg_lo:[1,0,0] neg_hi:[1,0,0]
  ds_write_addtid_b32 v185 offset:43584
  ds_write_addtid_b32 v187 offset:44112
  v_pk_fma_f32 v[170:171], v[174:175], v[148:149], v[170:171]
  v_pk_fma_f32 v[178:179], v[182:183], v[148:149], v[178:179]
  v_pk_mul_f32 v[156:157], v[152:153], v[148:149]
  v_pk_mul_f32 v[164:165], v[160:161], v[148:149]
  v_cvt_pk_bf16_f32 v188, v168, v169
  v_cvt_pk_bf16_f32 v190, v176, v177
  v_pk_mul_f32 v[158:159], v[152:153], v[150:151]
  v_pk_mul_f32 v[166:167], v[160:161], v[150:151]
  v_cvt_pk_bf16_f32 v189, v170, v171
  v_cvt_pk_bf16_f32 v191, v178, v179
  v_pk_fma_f32 v[156:157], v[154:155], v[150:151], v[156:157] neg_lo:[1,0,0] neg_hi:[1,0,0]
  v_pk_fma_f32 v[164:165], v[162:163], v[150:151], v[164:165] neg_lo:[1,0,0] neg_hi:[1,0,0]
  ds_write_addtid_b32 v188 offset:44384
  ds_write_addtid_b32 v190 offset:44912
  v_pk_fma_f32 v[158:159], v[154:155], v[148:149], v[158:159]
  v_pk_fma_f32 v[166:167], v[162:163], v[148:149], v[166:167]
  ds_write_addtid_b32 v189 offset:44640
  ds_write_addtid_b32 v191 offset:45168
  v_cvt_pk_bf16_f32 v184, v156, v157
  v_cvt_pk_bf16_f32 v186, v164, v165
  v_pk_mul_f32 v[172:173], v[168:169], v[148:149]
  v_pk_mul_f32 v[180:181], v[176:177], v[148:149]
  v_cvt_pk_bf16_f32 v185, v158, v159
  v_cvt_pk_bf16_f32 v187, v166, v167
  v_pk_mul_f32 v[174:175], v[168:169], v[150:151]
  v_pk_mul_f32 v[182:183], v[176:177], v[150:151]
  ds_write_addtid_b32 v184 offset:45440
  ds_write_addtid_b32 v186 offset:45968
  v_pk_fma_f32 v[172:173], v[170:171], v[150:151], v[172:173] neg_lo:[1,0,0] neg_hi:[1,0,0]
  v_pk_fma_f32 v[180:181], v[178:179], v[150:151], v[180:181] neg_lo:[1,0,0] neg_hi:[1,0,0]
  ds_write_addtid_b32 v185 offset:45696
  ds_write_addtid_b32 v187 offset:46224
  v_pk_fma_f32 v[174:175], v[170:171], v[148:149], v[174:175]
  v_pk_fma_f32 v[182:183], v[178:179], v[148:149], v[182:183]
  v_pk_mul_f32 v[152:153], v[156:157], v[148:149]
  v_pk_mul_f32 v[160:161], v[164:165], v[148:149]
  v_cvt_pk_bf16_f32 v188, v172, v173
  v_cvt_pk_bf16_f32 v190, v180, v181
  v_pk_mul_f32 v[154:155], v[156:157], v[150:151]
  v_pk_mul_f32 v[162:163], v[164:165], v[150:151]
  v_cvt_pk_bf16_f32 v189, v174, v175
  v_cvt_pk_bf16_f32 v191, v182, v183
  v_pk_fma_f32 v[152:153], v[158:159], v[150:151], v[152:153] neg_lo:[1,0,0] neg_hi:[1,0,0]
  v_pk_fma_f32 v[160:161], v[166:167], v[150:151], v[160:161] neg_lo:[1,0,0] neg_hi:[1,0,0]
  ds_write_addtid_b32 v188 offset:46496
  ds_write_addtid_b32 v190 offset:47024
  v_pk_fma_f32 v[154:155], v[158:159], v[148:149], v[154:155]
  v_pk_fma_f32 v[162:163], v[166:167], v[148:149], v[162:163]
  ds_write_addtid_b32 v189 offset:46752
  ds_write_addtid_b32 v191 offset:47280
  v_cvt_pk_bf16_f32 v184, v152, v153
  v_cvt_pk_bf16_f32 v186, v160, v161
  v_pk_mul_f32 v[168:169], v[172:173], v[148:149]
  v_cvt_pk_bf16_f32 v185, v154, v155
  v_cvt_pk_bf16_f32 v187, v162, v163
  v_pk_mul_f32 v[170:171], v[172:173], v[150:151]
  ds_write_addtid_b32 v184 offset:47552
  ds_write_addtid_b32 v186 offset:48080
  v_pk_fma_f32 v[168:169], v[174:175], v[150:151], v[168:169] neg_lo:[1,0,0] neg_hi:[1,0,0]
  ds_write_addtid_b32 v185 offset:47808
  ds_write_addtid_b32 v187 offset:48336
  v_pk_fma_f32 v[170:171], v[174:175], v[148:149], v[170:171]
  v_cvt_pk_bf16_f32 v188, v168, v169
  v_cvt_pk_bf16_f32 v189, v170, v171
  ds_write_addtid_b32 v188 offset:48608
  ds_write_addtid_b32 v189 offset:48864
  s_setprio 1
  s_waitcnt vmcnt(0) lgkmcnt(0)
  s_barrier
  ds_read_b128 v[16:19], v8 offset:0
  ds_read_b128 v[20:23], v8 offset:4096
  ds_read_b64_tr_b16 v[24:25], v12 offset:8192
  ds_read_b64_tr_b16 v[26:27], v12 offset:9216
  ds_read_b64_tr_b16 v[28:29], v13 offset:8192
  ds_read_b64_tr_b16 v[30:31], v13 offset:9216
  ds_read_b64_tr_b16 v[32:33], v14 offset:8192
  ds_read_b64_tr_b16 v[34:35], v14 offset:9216
  ds_read_b64_tr_b16 v[36:37], v15 offset:8192
  ds_read_b64_tr_b16 v[38:39], v15 offset:9216
  s_waitcnt lgkmcnt(0)
  v_mfma_f32_32x32x16_bf16 v[160:175], v[28:31], v[20:23], 0
  ds_read_b128 v[40:43], v9 offset:0
  ds_read_b128 v[44:47], v9 offset:4096
  v_mfma_f32_32x32x16_bf16 v[176:191], v[36:39], v[20:23], 0
  ds_read_b64_tr_b16 v[48:49], v12 offset:12288
  ds_read_b64_tr_b16 v[50:51], v12 offset:13312
  v_mfma_f32_32x32x16_bf16 v[128:143], v[24:27], v[20:23], 0
  ds_read_b64_tr_b16 v[52:53], v13 offset:12288
  ds_read_b64_tr_b16 v[54:55], v13 offset:13312
  v_mfma_f32_32x32x16_bf16 v[144:159], v[32:35], v[20:23], 0
  ds_read_b64_tr_b16 v[56:57], v14 offset:12288
  ds_read_b64_tr_b16 v[58:59], v14 offset:13312
  v_mfma_f32_32x32x16_bf16 v[96:111], v[28:31], v[16:19], 0
  ds_read_b64_tr_b16 v[60:61], v15 offset:12288
  ds_read_b64_tr_b16 v[62:63], v15 offset:13312
  v_mfma_f32_32x32x16_bf16 v[112:127], v[36:39], v[16:19], 0
  s_cmp_eq_u32 s43, 0
  s_cbranch_scc0 CS_14
  v_mfma_f32_32x32x16_bf16 v[224:239], v[200:203], v[24:27], 0
  v_mfma_f32_32x32x16_bf16 v[240:255], v[200:203], v[28:31], 0
CS_14:
  v_mfma_f32_32x32x16_bf16 v[64:79], v[24:27], v[16:19], 0
  s_cmp_eq_u32 s43, 1
  s_cbranch_scc0 CS_15
  v_mfma_f32_32x32x16_bf16 v[224:239], v[200:203], v[32:35], 0
  v_mfma_f32_32x32x16_bf16 v[240:255], v[200:203], v[36:39], 0
CS_15:
  v_mfma_f32_32x32x16_bf16 v[80:95], v[32:35], v[16:19], 0
  s_waitcnt lgkmcnt(0)
  s_barrier
  v_mfma_f32_32x32x16_bf16 v[160:175], v[52:55], v[44:47], v[160:175]
  ds_read_b128 v[16:19], v10 offset:0
  ds_read_b128 v[20:23], v10 offset:4096
  v_mfma_f32_32x32x16_bf16 v[176:191], v[60:63], v[44:47], v[176:191]
  ds_read_b64_tr_b16 v[24:25], v12 offset:16384
  ds_read_b64_tr_b16 v[26:27], v12 offset:17408
  v_mfma_f32_32x32x16_bf16 v[128:143], v[48:51], v[44:47], v[128:143]
  ds_read_b64_tr_b16 v[28:29], v13 offset:16384
  ds_read_b64_tr_b16 v[30:31], v13 offset:17408
  v_mfma_f32_32x32x16_bf16 v[144:159], v[56:59], v[44:47], v[144:159]
  ds_read_b64_tr_b16 v[32:33], v14 offset:16384
  ds_read_b64_tr_b16 v[34:35], v14 offset:17408
  v_mfma_f32_32x32x16_bf16 v[96:111], v[52:55], v[40:43], v[96:111]
  ds_read_b64_tr_b16 v[36:37], v15 offset:16384
  ds_read_b64_tr_b16 v[38:39], v15 offset:17408
  v_mfma_f32_32x32x16_bf16 v[112:127], v[60:63], v[40:43], v[112:127]
  s_cmp_eq_u32 s43, 0
  s_cbranch_scc0 CS_16
  v_mfma_f32_32x32x16_bf16 v[224:239], v[200:203], v[48:51], v[224:239]
  v_mfma_f32_32x32x16_bf16 v[240:255], v[200:203], v[52:55], v[240:255]
CS_16:
  v_mfma_f32_32x32x16_bf16 v[64:79], v[48:51], v[40:43], v[64:79]
  s_cmp_eq_u32 s43, 1
  s_cbranch_scc0 CS_17
  v_mfma_f32_32x32x16_bf16 v[224:239], v[200:203], v[56:59], v[224:239]
  v_mfma_f32_32x32x16_bf16 v[240:255], v[200:203], v[60:63], v[240:255]
CS_17:
  v_mfma_f32_32x32x16_bf16 v[80:95], v[56:59], v[40:43], v[80:95]
  s_waitcnt lgkmcnt(0)
  v_mfma_f32_32x32x16_bf16 v[160:175], v[28:31], v[20:23], v[160:175]
  ds_read_b128 v[40:43], v11 offset:0
  ds_read_b128 v[44:47], v11 offset:4096
  v_mfma_f32_32x32x16_bf16 v[176:191], v[36:39], v[20:23], v[176:191]
  ds_read_b64_tr_b16 v[48:49], v12 offset:20480
  ds_read_b64_tr_b16 v[50:51], v12 offset:21504
  v_mfma_f32_32x32x16_bf16 v[128:143], v[24:27], v[20:23], v[128:143]
  ds_read_b64_tr_b16 v[52:53], v13 offset:20480
  ds_read_b64_tr_b16 v[54:55], v13 offset:21504
  v_mfma_f32_32x32x16_bf16 v[144:159], v[32:35], v[20:23], v[144:159]
  ds_read_b64_tr_b16 v[56:57], v14 offset:20480
  ds_read_b64_tr_b16 v[58:59], v14 offset:21504
  v_mfma_f32_32x32x16_bf16 v[96:111], v[28:31], v[16:19], v[96:111]
  ds_read_b64_tr_b16 v[60:61], v15 offset:20480
  ds_read_b64_tr_b16 v[62:63], v15 offset:21504
  v_mfma_f32_32x32x16_bf16 v[112:127], v[36:39], v[16:19], v[112:127]
  s_cmp_eq_u32 s43, 2
  s_cbranch_scc0 CS_18
  v_mfma_f32_32x32x16_bf16 v[224:239], v[200:203], v[24:27], 0
  v_mfma_f32_32x32x16_bf16 v[240:255], v[200:203], v[28:31], 0
CS_18:
  v_mfma_f32_32x32x16_bf16 v[64:79], v[24:27], v[16:19], v[64:79]
  s_cmp_eq_u32 s43, 3
  s_cbranch_scc0 CS_19
  v_mfma_f32_32x32x16_bf16 v[224:239], v[200:203], v[32:35], 0
  v_mfma_f32_32x32x16_bf16 v[240:255], v[200:203], v[36:39], 0
CS_19:
  v_mfma_f32_32x32x16_bf16 v[80:95], v[32:35], v[16:19], v[80:95]
  s_waitcnt lgkmcnt(0)
  s_barrier
  v_mfma_f32_32x32x16_bf16 v[160:175], v[52:55], v[44:47], v[160:175]
  ds_read_b128 v[16:19], v8 offset:16384
  ds_read_b128 v[20:23], v8 offset:20480
  v_mfma_f32_32x32x16_bf16 v[176:191], v[60:63], v[44:47], v[176:191]
  ds_read_b64_tr_b16 v[24:25], v12 offset:24576
  ds_read_b64_tr_b16 v[26:27], v12 offset:25600
  v_mfma_f32_32x32x16_bf16 v[128:143], v[48:51], v[44:47], v[128:143]
  ds_read_b64_tr_b16 v[28:29], v13 offset:24576
  ds_read_b64_tr_b16 v[30:31], v13 offset:25600
  v_mfma_f32_32x32x16_bf16 v[144:159], v[56:59], v[44:47], v[144:159]
  ds_read_b64_tr_b16 v[32:33], v14 offset:24576
  ds_read_b64_tr_b16 v[34:35], v14 offset:25600
  v_mfma_f32_32x32x16_bf16 v[96:111], v[52:55], v[40:43], v[96:111]
  ds_read_b64_tr_b16 v[36:37], v15 offset:24576
  ds_read_b64_tr_b16 v[38:39], v15 offset:25600
  v_mfma_f32_32x32x16_bf16 v[112:127], v[60:63], v[40:43], v[112:127]
  s_cmp_eq_u32 s43, 2
  s_cbranch_scc0 CS_20
  v_mfma_f32_32x32x16_bf16 v[224:239], v[200:203], v[48:51], v[224:239]
  v_mfma_f32_32x32x16_bf16 v[240:255], v[200:203], v[52:55], v[240:255]
CS_20:
  v_mfma_f32_32x32x16_bf16 v[64:79], v[48:51], v[40:43], v[64:79]
  s_cmp_eq_u32 s43, 3
  s_cbranch_scc0 CS_21
  v_mfma_f32_32x32x16_bf16 v[224:239], v[200:203], v[56:59], v[224:239]
  v_mfma_f32_32x32x16_bf16 v[240:255], v[200:203], v[60:63], v[240:255]
CS_21:
  v_mfma_f32_32x32x16_bf16 v[80:95], v[56:59], v[40:43], v[80:95]
  s_waitcnt lgkmcnt(0)
  v_mfma_f32_32x32x16_bf16 v[160:175], v[28:31], v[20:23], v[160:175]
  ds_read_b128 v[40:43], v9 offset:16384
  ds_read_b128 v[44:47], v9 offset:20480
  v_mfma_f32_32x32x16_bf16 v[176:191], v[36:39], v[20:23], v[176:191]
  ds_read_b64_tr_b16 v[48:49], v12 offset:28672
  ds_read_b64_tr_b16 v[50:51], v12 offset:29696
  v_mfma_f32_32x32x16_bf16 v[128:143], v[24:27], v[20:23], v[128:143]
  ds_read_b64_tr_b16 v[52:53], v13 offset:28672
  ds_read_b64_tr_b16 v[54:55], v13 offset:29696
  v_mfma_f32_32x32x16_bf16 v[144:159], v[32:35], v[20:23], v[144:159]
  ds_read_b64_tr_b16 v[56:57], v14 offset:28672
  ds_read_b64_tr_b16 v[58:59], v14 offset:29696
  v_mfma_f32_32x32x16_bf16 v[96:111], v[28:31], v[16:19], v[96:111]
  ds_read_b64_tr_b16 v[60:61], v15 offset:28672
  ds_read_b64_tr_b16 v[62:63], v15 offset:29696
  v_mfma_f32_32x32x16_bf16 v[112:127], v[36:39], v[16:19], v[112:127]
  s_cmp_eq_u32 s43, 4
  s_cbranch_scc0 CS_22
  v_mfma_f32_32x32x16_bf16 v[224:239], v[200:203], v[24:27], 0
  v_mfma_f32_32x32x16_bf16 v[240:255], v[200:203], v[28:31], 0
CS_22:
  v_mfma_f32_32x32x16_bf16 v[64:79], v[24:27], v[16:19], v[64:79]
  s_cmp_eq_u32 s43, 5
  s_cbranch_scc0 CS_23
  v_mfma_f32_32x32x16_bf16 v[224:239], v[200:203], v[32:35], 0
  v_mfma_f32_32x32x16_bf16 v[240:255], v[200:203], v[36:39], 0
CS_23:
  v_mfma_f32_32x32x16_bf16 v[80:95], v[32:35], v[16:19], v[80:95]
  s_waitcnt lgkmcnt(0)
  s_barrier
  v_mfma_f32_32x32x16_bf16 v[160:175], v[52:55], v[44:47], v[160:175]
  ds_read_b128 v[16:19], v10 offset:16384
  ds_read_b128 v[20:23], v10 offset:20480
  v_mfma_f32_32x32x16_bf16 v[176:191], v[60:63], v[44:47], v[176:191]
  ds_read_b64_tr_b16 v[24:25], v12 offset:0
  ds_read_b64_tr_b16 v[26:27], v12 offset:1024
  v_mfma_f32_32x32x16_bf16 v[128:143], v[48:51], v[44:47], v[128:143]
  ds_read_b64_tr_b16 v[28:29], v13 offset:0
  ds_read_b64_tr_b16 v[30:31], v13 offset:1024
  v_mfma_f32_32x32x16_bf16 v[144:159], v[56:59], v[44:47], v[144:159]
  ds_read_b64_tr_b16 v[32:33], v14 offset:0
  ds_read_b64_tr_b16 v[34:35], v14 offset:1024
  v_mfma_f32_32x32x16_bf16 v[96:111], v[52:55], v[40:43], v[96:111]
  ds_read_b64_tr_b16 v[36:37], v15 offset:0
  ds_read_b64_tr_b16 v[38:39], v15 offset:1024
  v_mfma_f32_32x32x16_bf16 v[112:127], v[60:63], v[40:43], v[112:127]
  s_cmp_eq_u32 s43, 4
  s_cbranch_scc0 CS_24
  v_mfma_f32_32x32x16_bf16 v[224:239], v[200:203], v[48:51], v[224:239]
  v_mfma_f32_32x32x16_bf16 v[240:255], v[200:203], v[52:55], v[240:255]
CS_24:
  v_mfma_f32_32x32x16_bf16 v[64:79], v[48:51], v[40:43], v[64:79]
  s_cmp_eq_u32 s43, 5
  s_cbranch_scc0 CS_25
  v_mfma_f32_32x32x16_bf16 v[224:239], v[200:203], v[56:59], v[224:239]
  v_mfma_f32_32x32x16_bf16 v[240:255], v[200:203], v[60:63], v[240:255]
CS_25:
  v_mfma_f32_32x32x16_bf16 v[80:95], v[56:59], v[40:43], v[80:95]
  s_waitcnt lgkmcnt(0)
  v_mfma_f32_32x32x16_bf16 v[160:175], v[28:31], v[20:23], v[160:175]
  ds_read_b128 v[40:43], v11 offset:16384
  ds_read_b128 v[44:47], v11 offset:20480
  v_mfma_f32_32x32x16_bf16 v[176:191], v[36:39], v[20:23], v[176:191]
  ds_read_b64_tr_b16 v[48:49], v12 offset:4096
  ds_read_b64_tr_b16 v[50:51], v12 offset:5120
  v_mfma_f32_32x32x16_bf16 v[128:143], v[24:27], v[20:23], v[128:143]
  ds_read_b64_tr_b16 v[52:53], v13 offset:4096
  ds_read_b64_tr_b16 v[54:55], v13 offset:5120
  v_mfma_f32_32x32x16_bf16 v[144:159], v[32:35], v[20:23], v[144:159]
  ds_read_b64_tr_b16 v[56:57], v14 offset:4096
  ds_read_b64_tr_b16 v[58:59], v14 offset:5120
  v_mfma_f32_32x32x16_bf16 v[96:111], v[28:31], v[16:19], v[96:111]
  ds_read_b64_tr_b16 v[60:61], v15 offset:4096
  ds_read_b64_tr_b16 v[62:63], v15 offset:5120
  v_mfma_f32_32x32x16_bf16 v[112:127], v[36:39], v[16:19], v[112:127]
  s_cmp_eq_u32 s43, 6
  s_cbranch_scc0 CS_26
  v_mfma_f32_32x32x16_bf16 v[224:239], v[200:203], v[24:27], 0
  v_mfma_f32_32x32x16_bf16 v[240:255], v[200:203], v[28:31], 0
CS_26:
  v_mfma_f32_32x32x16_bf16 v[64:79], v[24:27], v[16:19], v[64:79]
  s_cmp_eq_u32 s43, 7
  s_cbranch_scc0 CS_27
  v_mfma_f32_32x32x16_bf16 v[224:239], v[200:203], v[32:35], 0
  v_mfma_f32_32x32x16_bf16 v[240:255], v[200:203], v[36:39], 0
CS_27:
  v_mfma_f32_32x32x16_bf16 v[80:95], v[32:35], v[16:19], v[80:95]
  s_waitcnt lgkmcnt(0)
  s_barrier
  v_mfma_f32_32x32x16_bf16 v[160:175], v[52:55], v[44:47], v[160:175]
  ds_read_b128 v[16:19], v8 offset:32768
  ds_read_b128 v[20:23], v8 offset:36864
  v_mfma_f32_32x32x16_bf16 v[176:191], v[60:63], v[44:47], v[176:191]
  ds_read_b64_tr_b16 v[24:25], v12 offset:8192
  ds_read_b64_tr_b16 v[26:27], v12 offset:9216
  v_mfma_f32_32x32x16_bf16 v[128:143], v[48:51], v[44:47], v[128:143]
  ds_read_b64_tr_b16 v[28:29], v13 offset:8192
  ds_read_b64_tr_b16 v[30:31], v13 offset:9216
  v_mfma_f32_32x32x16_bf16 v[144:159], v[56:59], v[44:47], v[144:159]
  ds_read_b64_tr_b16 v[32:33], v14 offset:8192
  ds_read_b64_tr_b16 v[34:35], v14 offset:9216
  v_mfma_f32_32x32x16_bf16 v[96:111], v[52:55], v[40:43], v[96:111]
  ds_read_b64_tr_b16 v[36:37], v15 offset:8192
  ds_read_b64_tr_b16 v[38:39], v15 offset:9216
  v_mfma_f32_32x32x16_bf16 v[112:127], v[60:63], v[40:43], v[112:127]
  s_cmp_eq_u32 s43, 6
  s_cbranch_scc0 CS_28
  v_mfma_f32_32x32x16_bf16 v[224:239], v[200:203], v[48:51], v[224:239]
  v_mfma_f32_32x32x16_bf16 v[240:255], v[200:203], v[52:55], v[240:255]
CS_28:
  v_mfma_f32_32x32x16_bf16 v[64:79], v[48:51], v[40:43], v[64:79]
  s_cmp_eq_u32 s43, 7
  s_cbranch_scc0 CS_29
  v_mfma_f32_32x32x16_bf16 v[224:239], v[200:203], v[56:59], v[224:239]
  v_mfma_f32_32x32x16_bf16 v[240:255], v[200:203], v[60:63], v[240:255]
CS_29:
  v_mfma_f32_32x32x16_bf16 v[80:95], v[56:59], v[40:43], v[80:95]
  s_waitcnt lgkmcnt(0)
  v_mfma_f32_32x32x16_bf16 v[160:175], v[28:31], v[20:23], v[160:175]
  ds_read_b128 v[40:43], v9 offset:32768
  ds_read_b128 v[44:47], v9 offset:36864
  v_mfma_f32_32x32x16_bf16 v[176:191], v[36:39], v[20:23], v[176:191]
  ds_read_b64_tr_b16 v[48:49], v12 offset:12288
  ds_read_b64_tr_b16 v[50:51], v12 offset:13312
  v_mfma_f32_32x32x16_bf16 v[128:143], v[24:27], v[20:23], v[128:143]
  ds_read_b64_tr_b16 v[52:53], v13 offset:12288
  ds_read_b64_tr_b16 v[54:55], v13 offset:13312
  v_mfma_f32_32x32x16_bf16 v[144:159], v[32:35], v[20:23], v[144:159]
  ds_read_b64_tr_b16 v[56:57], v14 offset:12288
  ds_read_b64_tr_b16 v[58:59], v14 offset:13312
  v_mfma_f32_32x32x16_bf16 v[96:111], v[28:31], v[16:19], v[96:111]
  ds_read_b64_tr_b16 v[60:61], v15 offset:12288
  ds_read_b64_tr_b16 v[62:63], v15 offset:13312
  v_mfma_f32_32x32x16_bf16 v[112:127], v[36:39], v[16:19], v[112:127]
  s_cmp_ge_u32 s43, 14
  s_cbranch_scc1 CS_X
  v_cndmask_b32 v206, v240, v224, vcc
  v_mov_b32 v207, s20
  buffer_store_dwordx2 v[206:207], v6, s[16:19], s42 offen sc1
CS_X:
  v_mfma_f32_32x32x16_bf16 v[64:79], v[24:27], v[16:19], v[64:79]
  v_mfma_f32_32x32x16_bf16 v[80:95], v[32:35], v[16:19], v[80:95]
  s_waitcnt lgkmcnt(0)
  s_barrier
  v_mfma_f32_32x32x16_bf16 v[160:175], v[52:55], v[44:47], v[160:175]
  ds_read_b128 v[16:19], v10 offset:32768
  ds_read_b128 v[20:23], v10 offset:36864
  v_mfma_f32_32x32x16_bf16 v[176:191], v[60:63], v[44:47], v[176:191]
  ds_read_b64_tr_b16 v[24:25], v12 offset:16384
  ds_read_b64_tr_b16 v[26:27], v12 offset:17408
  v_mfma_f32_32x32x16_bf16 v[128:143], v[48:51], v[44:47], v[128:143]
  ds_read_b64_tr_b16 v[28:29], v13 offset:16384
  ds_read_b64_tr_b16 v[30:31], v13 offset:17408
  v_mfma_f32_32x32x16_bf16 v[144:159], v[56:59], v[44:47], v[144:159]
  ds_read_b64_tr_b16 v[32:33], v14 offset:16384
  ds_read_b64_tr_b16 v[34:35], v14 offset:17408
  v_mfma_f32_32x32x16_bf16 v[96:111], v[52:55], v[40:43], v[96:111]
  ds_read_b64_tr_b16 v[36:37], v15 offset:16384
  ds_read_b64_tr_b16 v[38:39], v15 offset:17408
  v_mfma_f32_32x32x16_bf16 v[112:127], v[60:63], v[40:43], v[112:127]
  s_cmp_lg_u32 s3, 0
  s_cbranch_scc1 CS_Y
  s_mov_b64 exec, 1
  v_mov_b32 v208, s20
  buffer_store_dword v208, off, s[16:19], s45 sc1
  s_mov_b64 exec, -1
CS_Y:
  v_mfma_f32_32x32x16_bf16 v[64:79], v[48:51], v[40:43], v[64:79]
  v_mfma_f32_32x32x16_bf16 v[80:95], v[56:59], v[40:43], v[80:95]
  s_waitcnt lgkmcnt(0)
  v_mfma_f32_32x32x16_bf16 v[160:175], v[28:31], v[20:23], v[160:175]
  ds_read_b128 v[40:43], v11 offset:32768
  ds_read_b128 v[44:47], v11 offset:36864
  v_mfma_f32_32x32x16_bf16 v[176:191], v[36:39], v[20:23], v[176:191]
  ds_read_b64_tr_b16 v[48:49], v12 offset:20480
  ds_read_b64_tr_b16 v[50:51], v12 offset:21504
  v_mfma_f32_32x32x16_bf16 v[128:143], v[24:27], v[20:23], v[128:143]
  ds_read_b64_tr_b16 v[52:53], v13 offset:20480
  ds_read_b64_tr_b16 v[54:55], v13 offset:21504
  v_mfma_f32_32x32x16_bf16 v[144:159], v[32:35], v[20:23], v[144:159]
  ds_read_b64_tr_b16 v[56:57], v14 offset:20480
  ds_read_b64_tr_b16 v[58:59], v14 offset:21504
  v_mfma_f32_32x32x16_bf16 v[96:111], v[28:31], v[16:19], v[96:111]
  ds_read_b64_tr_b16 v[60:61], v15 offset:20480
  ds_read_b64_tr_b16 v[62:63], v15 offset:21504
  v_mfma_f32_32x32x16_bf16 v[112:127], v[36:39], v[16:19], v[112:127]
  v_mfma_f32_32x32x16_bf16 v[64:79], v[24:27], v[16:19], v[64:79]
  v_mfma_f32_32x32x16_bf16 v[80:95], v[32:35], v[16:19], v[80:95]
  s_waitcnt lgkmcnt(0)
  s_barrier
  v_mfma_f32_32x32x16_bf16 v[160:175], v[52:55], v[44:47], v[160:175]
  ds_read_b128 v[16:19], v8 offset:0
  ds_read_b128 v[20:23], v8 offset:4096
  v_mfma_f32_32x32x16_bf16 v[176:191], v[60:63], v[44:47], v[176:191]
  ds_read_b64_tr_b16 v[24:25], v12 offset:24576
  ds_read_b64_tr_b16 v[26:27], v12 offset:25600
  v_mfma_f32_32x32x16_bf16 v[128:143], v[48:51], v[44:47], v[128:143]
  ds_read_b64_tr_b16 v[28:29], v13 offset:24576
  ds_read_b64_tr_b16 v[30:31], v13 offset:25600
  v_mfma_f32_32x32x16_bf16 v[144:159], v[56:59], v[44:47], v[144:159]
  ds_read_b64_tr_b16 v[32:33], v14 offset:24576
  ds_read_b64_tr_b16 v[34:35], v14 offset:25600
  v_mfma_f32_32x32x16_bf16 v[96:111], v[52:55], v[40:43], v[96:111]
  ds_read_b64_tr_b16 v[36:37], v15 offset:24576
  ds_read_b64_tr_b16 v[38:39], v15 offset:25600
  v_mfma_f32_32x32x16_bf16 v[112:127], v[60:63], v[40:43], v[112:127]
  v_mfma_f32_32x32x16_bf16 v[64:79], v[48:51], v[40:43], v[64:79]
  v_mfma_f32_32x32x16_bf16 v[80:95], v[56:59], v[40:43], v[80:95]
  s_waitcnt lgkmcnt(0)
  v_mfma_f32_32x32x16_bf16 v[160:175], v[28:31], v[20:23], v[160:175]
  ds_read_b128 v[40:43], v9 offset:0
  ds_read_b128 v[44:47], v9 offset:4096
  v_mfma_f32_32x32x16_bf16 v[176:191], v[36:39], v[20:23], v[176:191]
  ds_read_b64_tr_b16 v[48:49], v12 offset:28672
  ds_read_b64_tr_b16 v[50:51], v12 offset:29696
  v_mfma_f32_32x32x16_bf16 v[128:143], v[24:27], v[20:23], v[128:143]
  ds_read_b64_tr_b16 v[52:53], v13 offset:28672
  ds_read_b64_tr_b16 v[54:55], v13 offset:29696
  v_mfma_f32_32x32x16_bf16 v[144:159], v[32:35], v[20:23], v[144:159]
  ds_read_b64_tr_b16 v[56:57], v14 offset:28672
  ds_read_b64_tr_b16 v[58:59], v14 offset:29696
  v_mfma_f32_32x32x16_bf16 v[96:111], v[28:31], v[16:19], v[96:111]
  ds_read_b64_tr_b16 v[60:61], v15 offset:28672
  ds_read_b64_tr_b16 v[62:63], v15 offset:29696
  v_mfma_f32_32x32x16_bf16 v[112:127], v[36:39], v[16:19], v[112:127]
  v_mfma_f32_32x32x16_bf16 v[64:79], v[24:27], v[16:19], v[64:79]
  v_mfma_f32_32x32x16_bf16 v[80:95], v[32:35], v[16:19], v[80:95]
  s_waitcnt lgkmcnt(0)
  s_barrier
  v_mfma_f32_32x32x16_bf16 v[160:175], v[52:55], v[44:47], v[160:175]
  ds_read_b128 v[16:19], v10 offset:0
  ds_read_b128 v[20:23], v10 offset:4096
  v_mfma_f32_32x32x16_bf16 v[176:191], v[60:63], v[44:47], v[176:191]
  ds_read_b64_tr_b16 v[24:25], v12 offset:0
  ds_read_b64_tr_b16 v[26:27], v12 offset:1024
  v_mfma_f32_32x32x16_bf16 v[128:143], v[48:51], v[44:47], v[128:143]
  ds_read_b64_tr_b16 v[28:29], v13 offset:0
  ds_read_b64_tr_b16 v[30:31], v13 offset:1024
  v_mfma_f32_32x32x16_bf16 v[144:159], v[56:59], v[44:47], v[144:159]
  ds_read_b64_tr_b16 v[32:33], v14 offset:0
  ds_read_b64_tr_b16 v[34:35], v14 offset:1024
  v_mfma_f32_32x32x16_bf16 v[96:111], v[52:55], v[40:43], v[96:111]
  ds_read_b64_tr_b16 v[36:37], v15 offset:0
  ds_read_b64_tr_b16 v[38:39], v15 offset:1024
  v_mfma_f32_32x32x16_bf16 v[112:127], v[60:63], v[40:43], v[112:127]
  v_mfma_f32_32x32x16_bf16 v[64:79], v[48:51], v[40:43], v[64:79]
  v_mfma_f32_32x32x16_bf16 v[80:95], v[56:59], v[40:43], v[80:95]
  s_waitcnt lgkmcnt(0)
  v_mfma_f32_32x32x16_bf16 v[160:175], v[28:31], v[20:23], v[160:175]
  ds_read_b128 v[40:43], v11 offset:0
  ds_read_b128 v[44:47], v11 offset:4096
  v_mfma_f32_32x32x16_bf16 v[176:191], v[36:39], v[20:23], v[176:191]
  ds_read_b64_tr_b16 v[48:49], v12 offset:4096
  ds_read_b64_tr_b16 v[50:51], v12 offset:5120
  v_mfma_f32_32x32x16_bf16 v[128:143], v[24:27], v[20:23], v[128:143]
  ds_read_b64_tr_b16 v[52:53], v13 offset:4096
  ds_read_b64_tr_b16 v[54:55], v13 offset:5120
  v_mfma_f32_32x32x16_bf16 v[144:159], v[32:35], v[20:23], v[144:159]
  ds_read_b64_tr_b16 v[56:57], v14 offset:4096
  ds_read_b64_tr_b16 v[58:59], v14 offset:5120
  v_mfma_f32_32x32x16_bf16 v[96:111], v[28:31], v[16:19], v[96:111]
  ds_read_b64_tr_b16 v[60:61], v15 offset:4096
  ds_read_b64_tr_b16 v[62:63], v15 offset:5120
  v_mfma_f32_32x32x16_bf16 v[112:127], v[36:39], v[16:19], v[112:127]
  v_mfma_f32_32x32x16_bf16 v[64:79], v[24:27], v[16:19], v[64:79]
  v_mfma_f32_32x32x16_bf16 v[80:95], v[32:35], v[16:19], v[80:95]
  s_waitcnt lgkmcnt(0)
  s_barrier
  v_mfma_f32_32x32x16_bf16 v[160:175], v[52:55], v[44:47], v[160:175]
  ds_read_b128 v[16:19], v8 offset:16384
  ds_read_b128 v[20:23], v8 offset:20480
  v_mfma_f32_32x32x16_bf16 v[176:191], v[60:63], v[44:47], v[176:191]
  ds_read_b64_tr_b16 v[24:25], v12 offset:8192
  ds_read_b64_tr_b16 v[26:27], v12 offset:9216
  v_mfma_f32_32x32x16_bf16 v[128:143], v[48:51], v[44:47], v[128:143]
  ds_read_b64_tr_b16 v[28:29], v13 offset:8192
  ds_read_b64_tr_b16 v[30:31], v13 offset:9216
  v_mfma_f32_32x32x16_bf16 v[144:159], v[56:59], v[44:47], v[144:159]
  ds_read_b64_tr_b16 v[32:33], v14 offset:8192
  ds_read_b64_tr_b16 v[34:35], v14 offset:9216
  v_mfma_f32_32x32x16_bf16 v[96:111], v[52:55], v[40:43], v[96:111]
  ds_read_b64_tr_b16 v[36:37], v15 offset:8192
  ds_read_b64_tr_b16 v[38:39], v15 offset:9216
  v_mfma_f32_32x32x16_bf16 v[112:127], v[60:63], v[40:43], v[112:127]
  v_mfma_f32_32x32x16_bf16 v[64:79], v[48:51], v[40:43], v[64:79]
  v_mfma_f32_32x32x16_bf16 v[80:95], v[56:59], v[40:43], v[80:95]
  s_waitcnt lgkmcnt(0)
  v_mfma_f32_32x32x16_bf16 v[160:175], v[28:31], v[20:23], v[160:175]
  ds_read_b128 v[40:43], v9 offset:16384
  ds_read_b128 v[44:47], v9 offset:20480
  v_mfma_f32_32x32x16_bf16 v[176:191], v[36:39], v[20:23], v[176:191]
  ds_read_b64_tr_b16 v[48:49], v12 offset:12288
  ds_read_b64_tr_b16 v[50:51], v12 offset:13312
  v_mfma_f32_32x32x16_bf16 v[128:143], v[24:27], v[20:23], v[128:143]
  ds_read_b64_tr_b16 v[52:53], v13 offset:12288
  ds_read_b64_tr_b16 v[54:55], v13 offset:13312
  v_mfma_f32_32x32x16_bf16 v[144:159], v[32:35], v[20:23], v[144:159]
  ds_read_b64_tr_b16 v[56:57], v14 offset:12288
  ds_read_b64_tr_b16 v[58:59], v14 offset:13312
  v_mfma_f32_32x32x16_bf16 v[96:111], v[28:31], v[16:19], v[96:111]
  ds_read_b64_tr_b16 v[60:61], v15 offset:12288
  ds_read_b64_tr_b16 v[62:63], v15 offset:13312
  v_mfma_f32_32x32x16_bf16 v[112:127], v[36:39], v[16:19], v[112:127]
  v_mfma_f32_32x32x16_bf16 v[64:79], v[24:27], v[16:19], v[64:79]
  v_mfma_f32_32x32x16_bf16 v[80:95], v[32:35], v[16:19], v[80:95]
  s_waitcnt lgkmcnt(0)
  s_barrier
  v_mfma_f32_32x32x16_bf16 v[160:175], v[52:55], v[44:47], v[160:175]
  ds_read_b128 v[16:19], v10 offset:16384
  ds_read_b128 v[20:23], v10 offset:20480
  v_mfma_f32_32x32x16_bf16 v[176:191], v[60:63], v[44:47], v[176:191]
  ds_read_b64_tr_b16 v[24:25], v12 offset:16384
  ds_read_b64_tr_b16 v[26:27], v12 offset:17408
  v_mfma_f32_32x32x16_bf16 v[128:143], v[48:51], v[44:47], v[128:143]
  ds_read_b64_tr_b16 v[28:29], v13 offset:16384
  ds_read_b64_tr_b16 v[30:31], v13 offset:17408
  v_mfma_f32_32x32x16_bf16 v[144:159], v[56:59], v[44:47], v[144:159]
  ds_read_b64_tr_b16 v[32:33], v14 offset:16384
  ds_read_b64_tr_b16 v[34:35], v14 offset:17408
  v_mfma_f32_32x32x16_bf16 v[96:111], v[52:55], v[40:43], v[96:111]
  ds_read_b64_tr_b16 v[36:37], v15 offset:16384
  ds_read_b64_tr_b16 v[38:39], v15 offset:17408
  v_mfma_f32_32x32x16_bf16 v[112:127], v[60:63], v[40:43], v[112:127]
  v_mfma_f32_32x32x16_bf16 v[64:79], v[48:51], v[40:43], v[64:79]
  v_mfma_f32_32x32x16_bf16 v[80:95], v[56:59], v[40:43], v[80:95]
  s_waitcnt lgkmcnt(0)
  v_mfma_f32_32x32x16_bf16 v[160:175], v[28:31], v[20:23], v[160:175]
  ds_read_b128 v[40:43], v11 offset:16384
  ds_read_b128 v[44:47], v11 offset:20480
  v_mfma_f32_32x32x16_bf16 v[176:191], v[36:39], v[20:23], v[176:191]
  ds_read_b64_tr_b16 v[48:49], v12 offset:20480
  ds_read_b64_tr_b16 v[50:51], v12 offset:21504
  v_mfma_f32_32x32x16_bf16 v[128:143], v[24:27], v[20:23], v[128:143]
  ds_read_b64_tr_b16 v[52:53], v13 offset:20480
  ds_read_b64_tr_b16 v[54:55], v13 offset:21504
  v_mfma_f32_32x32x16_bf16 v[144:159], v[32:35], v[20:23], v[144:159]
  ds_read_b64_tr_b16 v[56:57], v14 offset:20480
  ds_read_b64_tr_b16 v[58:59], v14 offset:21504
  v_mfma_f32_32x32x16_bf16 v[96:111], v[28:31], v[16:19], v[96:111]
  ds_read_b64_tr_b16 v[60:61], v15 offset:20480
  ds_read_b64_tr_b16 v[62:63], v15 offset:21504
  v_mfma_f32_32x32x16_bf16 v[112:127], v[36:39], v[16:19], v[112:127]
  v_mfma_f32_32x32x16_bf16 v[64:79], v[24:27], v[16:19], v[64:79]
  v_mfma_f32_32x32x16_bf16 v[80:95], v[32:35], v[16:19], v[80:95]
  s_waitcnt lgkmcnt(0)
  s_barrier
  v_mfma_f32_32x32x16_bf16 v[160:175], v[52:55], v[44:47], v[160:175]
  ds_read_b128 v[16:19], v8 offset:32768
  ds_read_b128 v[20:23], v8 offset:36864
  v_mfma_f32_32x32x16_bf16 v[176:191], v[60:63], v[44:47], v[176:191]
  ds_read_b64_tr_b16 v[24:25], v12 offset:24576
  ds_read_b64_tr_b16 v[26:27], v12 offset:25600
  v_mfma_f32_32x32x16_bf16 v[128:143], v[48:51], v[44:47], v[128:143]
  ds_read_b64_tr_b16 v[28:29], v13 offset:24576
  ds_read_b64_tr_b16 v[30:31], v13 offset:25600
  v_mfma_f32_32x32x16_bf16 v[144:159], v[56:59], v[44:47], v[144:159]
  ds_read_b64_tr_b16 v[32:33], v14 offset:24576
  ds_read_b64_tr_b16 v[34:35], v14 offset:25600
  v_mfma_f32_32x32x16_bf16 v[96:111], v[52:55], v[40:43], v[96:111]
  ds_read_b64_tr_b16 v[36:37], v15 offset:24576
  ds_read_b64_tr_b16 v[38:39], v15 offset:25600
  v_mfma_f32_32x32x16_bf16 v[112:127], v[60:63], v[40:43], v[112:127]
  v_mfma_f32_32x32x16_bf16 v[64:79], v[48:51], v[40:43], v[64:79]
  v_mfma_f32_32x32x16_bf16 v[80:95], v[56:59], v[40:43], v[80:95]
  s_waitcnt lgkmcnt(0)
  v_mfma_f32_32x32x16_bf16 v[160:175], v[28:31], v[20:23], v[160:175]
  ds_read_b128 v[40:43], v9 offset:32768
  ds_read_b128 v[44:47], v9 offset:36864
  v_mfma_f32_32x32x16_bf16 v[176:191], v[36:39], v[20:23], v[176:191]
  ds_read_b64_tr_b16 v[48:49], v12 offset:28672
  ds_read_b64_tr_b16 v[50:51], v12 offset:29696
  v_mfma_f32_32x32x16_bf16 v[128:143], v[24:27], v[20:23], v[128:143]
  ds_read_b64_tr_b16 v[52:53], v13 offset:28672
  ds_read_b64_tr_b16 v[54:55], v13 offset:29696
  v_mfma_f32_32x32x16_bf16 v[144:159], v[32:35], v[20:23], v[144:159]
  ds_read_b64_tr_b16 v[56:57], v14 offset:28672
  ds_read_b64_tr_b16 v[58:59], v14 offset:29696
  v_mfma_f32_32x32x16_bf16 v[96:111], v[28:31], v[16:19], v[96:111]
  ds_read_b64_tr_b16 v[60:61], v15 offset:28672
  ds_read_b64_tr_b16 v[62:63], v15 offset:29696
  v_mfma_f32_32x32x16_bf16 v[112:127], v[36:39], v[16:19], v[112:127]
  v_mfma_f32_32x32x16_bf16 v[64:79], v[24:27], v[16:19], v[64:79]
  v_mfma_f32_32x32x16_bf16 v[80:95], v[32:35], v[16:19], v[80:95]
  s_waitcnt lgkmcnt(0)
  s_barrier
  v_mfma_f32_32x32x16_bf16 v[160:175], v[52:55], v[44:47], v[160:175]
  ds_read_b128 v[16:19], v10 offset:32768
  ds_read_b128 v[20:23], v10 offset:36864
  v_mfma_f32_32x32x16_bf16 v[176:191], v[60:63], v[44:47], v[176:191]
  ds_read_b64_tr_b16 v[24:25], v12 offset:0
  ds_read_b64_tr_b16 v[26:27], v12 offset:1024
  v_mfma_f32_32x32x16_bf16 v[128:143], v[48:51], v[44:47], v[128:143]
  ds_read_b64_tr_b16 v[28:29], v13 offset:0
  ds_read_b64_tr_b16 v[30:31], v13 offset:1024
  v_mfma_f32_32x32x16_bf16 v[144:159], v[56:59], v[44:47], v[144:159]
  ds_read_b64_tr_b16 v[32:33], v14 offset:0
  ds_read_b64_tr_b16 v[34:35], v14 offset:1024
  v_mfma_f32_32x32x16_bf16 v[96:111], v[52:55], v[40:43], v[96:111]
  ds_read_b64_tr_b16 v[36:37], v15 offset:0
  ds_read_b64_tr_b16 v[38:39], v15 offset:1024
  v_mfma_f32_32x32x16_bf16 v[112:127], v[60:63], v[40:43], v[112:127]
  v_mfma_f32_32x32x16_bf16 v[64:79], v[48:51], v[40:43], v[64:79]
  v_mfma_f32_32x32x16_bf16 v[80:95], v[56:59], v[40:43], v[80:95]
  s_waitcnt lgkmcnt(0)
  v_mfma_f32_32x32x16_bf16 v[160:175], v[28:31], v[20:23], v[160:175]
  ds_read_b128 v[40:43], v11 offset:32768
  ds_read_b128 v[44:47], v11 offset:36864
  v_mfma_f32_32x32x16_bf16 v[176:191], v[36:39], v[20:23], v[176:191]
  ds_read_b64_tr_b16 v[48:49], v12 offset:4096
  ds_read_b64_tr_b16 v[50:51], v12 offset:5120
  v_mfma_f32_32x32x16_bf16 v[128:143], v[24:27], v[20:23], v[128:143]
  ds_read_b64_tr_b16 v[52:53], v13 offset:4096
  ds_read_b64_tr_b16 v[54:55], v13 offset:5120
  v_mfma_f32_32x32x16_bf16 v[144:159], v[32:35], v[20:23], v[144:159]
  ds_read_b64_tr_b16 v[56:57], v14 offset:4096
  ds_read_b64_tr_b16 v[58:59], v14 offset:5120
  v_mfma_f32_32x32x16_bf16 v[96:111], v[28:31], v[16:19], v[96:111]
  ds_read_b64_tr_b16 v[60:61], v15 offset:4096
  ds_read_b64_tr_b16 v[62:63], v15 offset:5120
  v_mfma_f32_32x32x16_bf16 v[112:127], v[36:39], v[16:19], v[112:127]
  v_mfma_f32_32x32x16_bf16 v[64:79], v[24:27], v[16:19], v[64:79]
  v_mfma_f32_32x32x16_bf16 v[80:95], v[32:35], v[16:19], v[80:95]
  s_waitcnt lgkmcnt(0)
  s_barrier
  v_mfma_f32_32x32x16_bf16 v[160:175], v[52:55], v[44:47], v[160:175]
  ds_read_b128 v[16:19], v8 offset:0
  ds_read_b128 v[20:23], v8 offset:4096
  v_mfma_f32_32x32x16_bf16 v[176:191], v[60:63], v[44:47], v[176:191]
  ds_read_b64_tr_b16 v[24:25], v12 offset:8192
  ds_read_b64_tr_b16 v[26:27], v12 offset:9216
  v_mfma_f32_32x32x16_bf16 v[128:143], v[48:51], v[44:47], v[128:143]
  ds_read_b64_tr_b16 v[28:29], v13 offset:8192
  ds_read_b64_tr_b16 v[30:31], v13 offset:9216
  v_mfma_f32_32x32x16_bf16 v[144:159], v[56:59], v[44:47], v[144:159]
  ds_read_b64_tr_b16 v[32:33], v14 offset:8192
  ds_read_b64_tr_b16 v[34:35], v14 offset:9216
  v_mfma_f32_32x32x16_bf16 v[96:111], v[52:55], v[40:43], v[96:111]
  ds_read_b64_tr_b16 v[36:37], v15 offset:8192
  ds_read_b64_tr_b16 v[38:39], v15 offset:9216
  v_mfma_f32_32x32x16_bf16 v[112:127], v[60:63], v[40:43], v[112:127]
  v_mfma_f32_32x32x16_bf16 v[64:79], v[48:51], v[40:43], v[64:79]
  v_mfma_f32_32x32x16_bf16 v[80:95], v[56:59], v[40:43], v[80:95]
  s_waitcnt lgkmcnt(0)
  v_mfma_f32_32x32x16_bf16 v[160:175], v[28:31], v[20:23], v[160:175]
  ds_read_b128 v[40:43], v9 offset:0
  ds_read_b128 v[44:47], v9 offset:4096
  v_mfma_f32_32x32x16_bf16 v[176:191], v[36:39], v[20:23], v[176:191]
  ds_read_b64_tr_b16 v[48:49], v12 offset:12288
  ds_read_b64_tr_b16 v[50:51], v12 offset:13312
  v_mfma_f32_32x32x16_bf16 v[128:143], v[24:27], v[20:23], v[128:143]
  ds_read_b64_tr_b16 v[52:53], v13 offset:12288
  ds_read_b64_tr_b16 v[54:55], v13 offset:13312
  v_mfma_f32_32x32x16_bf16 v[144:159], v[32:35], v[20:23], v[144:159]
  ds_read_b64_tr_b16 v[56:57], v14 offset:12288
  ds_read_b64_tr_b16 v[58:59], v14 offset:13312
  v_mfma_f32_32x32x16_bf16 v[96:111], v[28:31], v[16:19], v[96:111]
  ds_read_b64_tr_b16 v[60:61], v15 offset:12288
  ds_read_b64_tr_b16 v[62:63], v15 offset:13312
  v_mfma_f32_32x32x16_bf16 v[112:127], v[36:39], v[16:19], v[112:127]
  v_mfma_f32_32x32x16_bf16 v[64:79], v[24:27], v[16:19], v[64:79]
  v_mfma_f32_32x32x16_bf16 v[80:95], v[32:35], v[16:19], v[80:95]
  s_waitcnt lgkmcnt(0)
  v_mfma_f32_32x32x16_bf16 v[160:175], v[52:55], v[44:47], v[160:175]
  ds_read_b128 v[16:19], v10 offset:0
  ds_read_b128 v[20:23], v10 offset:4096
  v_mfma_f32_32x32x16_bf16 v[176:191], v[60:63], v[44:47], v[176:191]
  ds_read_b64_tr_b16 v[24:25], v12 offset:16384
  ds_read_b64_tr_b16 v[26:27], v12 offset:17408
  v_mfma_f32_32x32x16_bf16 v[128:143], v[48:51], v[44:47], v[128:143]
  ds_read_b64_tr_b16 v[28:29], v13 offset:16384
  ds_read_b64_tr_b16 v[30:31], v13 offset:17408
  v_mfma_f32_32x32x16_bf16 v[144:159], v[56:59], v[44:47], v[144:159]
  ds_read_b64_tr_b16 v[32:33], v14 offset:16384
  ds_read_b64_tr_b16 v[34:35], v14 offset:17408
  v_mfma_f32_32x32x16_bf16 v[96:111], v[52:55], v[40:43], v[96:111]
  ds_read_b64_tr_b16 v[36:37], v15 offset:16384
  ds_read_b64_tr_b16 v[38:39], v15 offset:17408
  v_mfma_f32_32x32x16_bf16 v[112:127], v[60:63], v[40:43], v[112:127]
  v_mfma_f32_32x32x16_bf16 v[64:79], v[48:51], v[40:43], v[64:79]
  v_mfma_f32_32x32x16_bf16 v[80:95], v[56:59], v[40:43], v[80:95]
  s_waitcnt lgkmcnt(0)
  v_mfma_f32_32x32x16_bf16 v[160:175], v[28:31], v[20:23], v[160:175]
  ds_read_b128 v[40:43], v11 offset:0
  ds_read_b128 v[44:47], v11 offset:4096
  v_mfma_f32_32x32x16_bf16 v[176:191], v[36:39], v[20:23], v[176:191]
  ds_read_b64_tr_b16 v[48:49], v12 offset:20480
  ds_read_b64_tr_b16 v[50:51], v12 offset:21504
  v_mfma_f32_32x32x16_bf16 v[128:143], v[24:27], v[20:23], v[128:143]
  ds_read_b64_tr_b16 v[52:53], v13 offset:20480
  ds_read_b64_tr_b16 v[54:55], v13 offset:21504
  v_mfma_f32_32x32x16_bf16 v[144:159], v[32:35], v[20:23], v[144:159]
  ds_read_b64_tr_b16 v[56:57], v14 offset:20480
  ds_read_b64_tr_b16 v[58:59], v14 offset:21504
  v_mfma_f32_32x32x16_bf16 v[96:111], v[28:31], v[16:19], v[96:111]
  ds_read_b64_tr_b16 v[60:61], v15 offset:20480
  ds_read_b64_tr_b16 v[62:63], v15 offset:21504
  v_mfma_f32_32x32x16_bf16 v[112:127], v[36:39], v[16:19], v[112:127]
  ds_read_b32 v215, v214
  v_mfma_f32_32x32x16_bf16 v[64:79], v[24:27], v[16:19], v[64:79]
  v_mfma_f32_32x32x16_bf16 v[80:95], v[32:35], v[16:19], v[80:95]
  s_waitcnt lgkmcnt(0)
  v_mov_b32 v213, 2
  ds_write_b32 v7, v213
  s_mov_b32 s57, 0
  s_branch GT_1
GT_0:
  ds_read_b32 v215, v214
  s_add_u32 s57, s57, 1
  s_waitcnt lgkmcnt(0)
GT_1:
  v_cmp_gt_u32 s[62:63], 1, v215
  s_nop 1
  s_cmp_eq_u64 s[62:63], 0
  s_cbranch_scc1 GT_2
  s_cmp_lt_u32 s57, 320000
  s_cbranch_scc1 GT_0
GT_2:
  v_mfma_f32_32x32x16_bf16 v[160:175], v[52:55], v[44:47], v[160:175]
  ds_read_b128 v[192:195], v205 offset:0
  ds_read_b128 v[196:199], v205 offset:512
  v_mfma_f32_32x32x16_bf16 v[176:191], v[60:63], v[44:47], v[176:191]
  ds_read_b64 v[24:25], v204 offset:0
  ds_read_b64 v[28:29], v204 offset:256
  v_mfma_f32_32x32x16_bf16 v[128:143], v[48:51], v[44:47], v[128:143]
  ds_read_b64 v[32:33], v204 offset:1024
  ds_read_b64 v[36:37], v204 offset:1280
  v_mfma_f32_32x32x16_bf16 v[144:159], v[56:59], v[44:47], v[144:159]
  v_mov_b32 v18, 0
  v_mov_b32 v19, 0
  v_mov_b32 v22, 0
  v_mov_b32 v23, 0
  v_mfma_f32_32x32x16_bf16 v[96:111], v[52:55], v[40:43], v[96:111]
  v_mov_b32 v26, 0
  v_mov_b32 v27, 0
  v_mov_b32 v30, 0
  v_mov_b32 v31, 0
  v_mfma_f32_32x32x16_bf16 v[112:127], v[60:63], v[40:43], v[112:127]
  v_mov_b32 v34, 0
  v_mov_b32 v35, 0
  v_mov_b32 v38, 0
  v_mov_b32 v39, 0
  v_mfma_f32_32x32x16_bf16 v[64:79], v[48:51], v[40:43], v[64:79]
  v_mfma_f32_32x32x16_bf16 v[80:95], v[56:59], v[40:43], v[80:95]
  s_waitcnt lgkmcnt(0)
  v_cndmask_b32 v16, 0, v192, vcc
  v_and_b32 v17, 0xffff, v16
  v_cndmask_b32 v20, 0, v196, vcc
  v_and_b32 v21, 0xffff, v20
  s_nop 1
  v_mfma_f32_32x32x16_bf16 v[160:175], v[28:31], v[20:23], v[160:175]
  v_mov_b32 v192, v193
  v_mov_b32 v195, v194
  v_mov_b32 v196, v197
  v_mov_b32 v199, v198
  v_mfma_f32_32x32x16_bf16 v[176:191], v[36:39], v[20:23], v[176:191]
  v_mfma_f32_32x32x16_bf16 v[128:143], v[24:27], v[20:23], v[128:143]
  v_mfma_f32_32x32x16_bf16 v[144:159], v[32:35], v[20:23], v[144:159]
  v_mfma_f32_32x32x16_bf16 v[96:111], v[28:31], v[16:19], v[96:111]
  v_mfma_f32_32x32x16_bf16 v[112:127], v[36:39], v[16:19], v[112:127]
  v_mfma_f32_32x32x16_bf16 v[64:79], v[24:27], v[16:19], v[64:79]
  v_mfma_f32_32x32x16_bf16 v[80:95], v[32:35], v[16:19], v[80:95]
  s_setprio 1
  v_pk_mul_f32 v[160:161], v[160:161], v[196:197]
  v_pk_mul_f32 v[162:163], v[162:163], v[196:197]
  v_pk_mul_f32 v[164:165], v[164:165], v[196:197]
  v_pk_mul_f32 v[166:167], v[166:167], v[196:197]
  v_pk_mul_f32 v[168:169], v[168:169], v[196:197]
  v_pk_mul_f32 v[170:171], v[170:171], v[196:197]
  v_pk_mul_f32 v[172:173], v[172:173], v[196:197]
  v_pk_mul_f32 v[174:175], v[174:175], v[196:197]
  v_exp_f32 v160, v160
  v_exp_f32 v161, v161
  v_exp_f32 v162, v162
  v_exp_f32 v163, v163
  v_exp_f32 v164, v164
  v_exp_f32 v165, v165
  v_exp_f32 v166, v166
  v_exp_f32 v167, v167
  v_exp_f32 v168, v168
  v_exp_f32 v169, v169
  v_exp_f32 v170, v170
  v_exp_f32 v171, v171
  v_exp_f32 v172, v172
  v_exp_f32 v173, v173
  v_exp_f32 v174, v174
  v_exp_f32 v175, v175
  v_pk_fma_f32 v[160:161], v[160:161], v[198:199], v[198:199]
  v_pk_fma_f32 v[162:163], v[162:163], v[198:199], v[198:199]
  v_pk_fma_f32 v[164:165], v[164:165], v[198:199], v[198:199]
  v_pk_fma_f32 v[166:167], v[166:167], v[198:199], v[198:199]
  v_pk_fma_f32 v[168:169], v[168:169], v[198:199], v[198:199]
  v_pk_fma_f32 v[170:171], v[170:171], v[198:199], v[198:199]
  v_pk_fma_f32 v[172:173], v[172:173], v[198:199], v[198:199]
  v_pk_fma_f32 v[174:175], v[174:175], v[198:199], v[198:199]
  v_rcp_f32 v160, v160
  v_rcp_f32 v161, v161
  v_rcp_f32 v162, v162
  v_rcp_f32 v163, v163
  v_rcp_f32 v164, v164
  v_rcp_f32 v165, v165
  v_rcp_f32 v166, v166
  v_rcp_f32 v167, v167
  v_rcp_f32 v168, v168
  v_rcp_f32 v169, v169
  v_rcp_f32 v170, v170
  v_rcp_f32 v171, v171
  v_rcp_f32 v172, v172
  v_rcp_f32 v173, v173
  v_rcp_f32 v174, v174
  v_rcp_f32 v175, v175
  v_pk_mul_f32 v[176:177], v[176:177], v[160:161]
  v_pk_mul_f32 v[178:179], v[178:179], v[162:163]
  v_pk_mul_f32 v[180:181], v[180:181], v[164:165]
  v_pk_mul_f32 v[182:183], v[182:183], v[166:167]
  v_pk_mul_f32 v[184:185], v[184:185], v[168:169]
  v_pk_mul_f32 v[186:187], v[186:187], v[170:171]
  v_pk_mul_f32 v[188:189], v[188:189], v[172:173]
  v_pk_mul_f32 v[190:191], v[190:191], v[174:175]
  v_cvt_pk_bf16_f32 v160, v176, v177
  v_cvt_pk_bf16_f32 v161, v178, v179
  v_cvt_pk_bf16_f32 v162, v180, v181
  v_cvt_pk_bf16_f32 v163, v182, v183
  v_cvt_pk_bf16_f32 v164, v184, v185
  v_cvt_pk_bf16_f32 v165, v186, v187
  v_cvt_pk_bf16_f32 v166, v188, v189
  v_cvt_pk_bf16_f32 v167, v190, v191
  buffer_store_dwordx4 v[160:163], v2, s[16:19], s38 offen offset:2048 sc1
  buffer_store_dwordx4 v[164:167], v2, s[16:19], s38 offen offset:3072 sc1
  v_pk_mul_f32 v[128:129], v[128:129], v[196:197]
  v_pk_mul_f32 v[130:131], v[130:131], v[196:197]
  v_pk_mul_f32 v[132:133], v[132:133], v[196:197]
  v_pk_mul_f32 v[134:135], v[134:135], v[196:197]
  v_pk_mul_f32 v[136:137], v[136:137], v[196:197]
  v_pk_mul_f32 v[138:139], v[138:139], v[196:197]
  v_pk_mul_f32 v[140:141], v[140:141], v[196:197]
  v_pk_mul_f32 v[142:143], v[142:143], v[196:197]
  v_exp_f32 v128, v128
  v_exp_f32 v129, v129
  v_exp_f32 v130, v130
  v_exp_f32 v131, v131
  v_exp_f32 v132, v132
  v_exp_f32 v133, v133
  v_exp_f32 v134, v134
  v_exp_f32 v135, v135
  v_exp_f32 v136, v136
  v_exp_f32 v137, v137
  v_exp_f32 v138, v138
  v_exp_f32 v139, v139
  v_exp_f32 v140, v140
  v_exp_f32 v141, v141
  v_exp_f32 v142, v142
  v_exp_f32 v143, v143
  v_pk_fma_f32 v[128:129], v[128:129], v[198:199], v[198:199]
  v_pk_fma_f32 v[130:131], v[130:131], v[198:199], v[198:199]
  v_pk_fma_f32 v[132:133], v[132:133], v[198:199], v[198:199]
  v_pk_fma_f32 v[134:135], v[134:135], v[198:199], v[198:199]
  v_pk_fma_f32 v[136:137], v[136:137], v[198:199], v[198:199]
  v_pk_fma_f32 v[138:139], v[138:139], v[198:199], v[198:199]
  v_pk_fma_f32 v[140:141], v[140:141], v[198:199], v[198:199]
  v_pk_fma_f32 v[142:143], v[142:143], v[198:199], v[198:199]
  v_rcp_f32 v128, v128
  v_rcp_f32 v129, v129
  v_rcp_f32 v130, v130
  v_rcp_f32 v131, v131
  v_rcp_f32 v132, v132
  v_rcp_f32 v133, v133
  v_rcp_f32 v134, v134
  v_rcp_f32 v135, v135
  v_rcp_f32 v136, v136
  v_rcp_f32 v137, v137
  v_rcp_f32 v138, v138
  v_rcp_f32 v139, v139
  v_rcp_f32 v140, v140
  v_rcp_f32 v141, v141
  v_rcp_f32 v142, v142
  v_rcp_f32 v143, v143
  v_pk_mul_f32 v[144:145], v[144:145], v[128:129]
  v_pk_mul_f32 v[146:147], v[146:147], v[130:131]
  v_pk_mul_f32 v[148:149], v[148:149], v[132:133]
  v_pk_mul_f32 v[150:151], v[150:151], v[134:135]
  v_pk_mul_f32 v[152:153], v[152:153], v[136:137]
  v_pk_mul_f32 v[154:155], v[154:155], v[138:139]
  v_pk_mul_f32 v[156:157], v[156:157], v[140:141]
  v_pk_mul_f32 v[158:159], v[158:159], v[142:143]
  v_cvt_pk_bf16_f32 v128, v144, v145
  v_cvt_pk_bf16_f32 v129, v146, v147
  v_cvt_pk_bf16_f32 v130, v148, v149
  v_cvt_pk_bf16_f32 v131, v150, v151
  v_cvt_pk_bf16_f32 v132, v152, v153
  v_cvt_pk_bf16_f32 v133, v154, v155
  v_cvt_pk_bf16_f32 v134, v156, v157
  v_cvt_pk_bf16_f32 v135, v158, v159
  buffer_store_dwordx4 v[128:131], v2, s[16:19], s38 offen offset:0 sc1
  buffer_store_dwordx4 v[132:135], v2, s[16:19], s38 offen offset:1024 sc1
  v_pk_mul_f32 v[96:97], v[96:97], v[192:193]
  v_pk_mul_f32 v[98:99], v[98:99], v[192:193]
  v_pk_mul_f32 v[100:101], v[100:101], v[192:193]
  v_pk_mul_f32 v[102:103], v[102:103], v[192:193]
  v_pk_mul_f32 v[104:105], v[104:105], v[192:193]
  v_pk_mul_f32 v[106:107], v[106:107], v[192:193]
  v_pk_mul_f32 v[108:109], v[108:109], v[192:193]
  v_pk_mul_f32 v[110:111], v[110:111], v[192:193]
  v_exp_f32 v96, v96
  v_exp_f32 v97, v97
  v_exp_f32 v98, v98
  v_exp_f32 v99, v99
  v_exp_f32 v100, v100
  v_exp_f32 v101, v101
  v_exp_f32 v102, v102
  v_exp_f32 v103, v103
  v_exp_f32 v104, v104
  v_exp_f32 v105, v105
  v_exp_f32 v106, v106
  v_exp_f32 v107, v107
  v_exp_f32 v108, v108
  v_exp_f32 v109, v109
  v_exp_f32 v110, v110
  v_exp_f32 v111, v111
  v_pk_fma_f32 v[96:97], v[96:97], v[194:195], v[194:195]
  v_pk_fma_f32 v[98:99], v[98:99], v[194:195], v[194:195]
  v_pk_fma_f32 v[100:101], v[100:101], v[194:195], v[194:195]
  v_pk_fma_f32 v[102:103], v[102:103], v[194:195], v[194:195]
  v_pk_fma_f32 v[104:105], v[104:105], v[194:195], v[194:195]
  v_pk_fma_f32 v[106:107], v[106:107], v[194:195], v[194:195]
  v_pk_fma_f32 v[108:109], v[108:109], v[194:195], v[194:195]
  v_pk_fma_f32 v[110:111], v[110:111], v[194:195], v[194:195]
  v_rcp_f32 v96, v96
  v_rcp_f32 v97, v97
  v_rcp_f32 v98, v98
  v_rcp_f32 v99, v99
  v_rcp_f32 v100, v100
  v_rcp_f32 v101, v101
  v_rcp_f32 v102, v102
  v_rcp_f32 v103, v103
  v_rcp_f32 v104, v104
  v_rcp_f32 v105, v105
  v_rcp_f32 v106, v106
  v_rcp_f32 v107, v107
  v_rcp_f32 v108, v108
  v_rcp_f32 v109, v109
  v_rcp_f32 v110, v110
  v_rcp_f32 v111, v111
  v_pk_mul_f32 v[112:113], v[112:113], v[96:97]
  v_pk_mul_f32 v[114:115], v[114:115], v[98:99]
  v_pk_mul_f32 v[116:117], v[116:117], v[100:101]
  v_pk_mul_f32 v[118:119], v[118:119], v[102:103]
  v_pk_mul_f32 v[120:121], v[120:121], v[104:105]
  v_pk_mul_f32 v[122:123], v[122:123], v[106:107]
  v_pk_mul_f32 v[124:125], v[124:125], v[108:109]
  v_pk_mul_f32 v[126:127], v[126:127], v[110:111]
  v_cvt_pk_bf16_f32 v96, v112, v113
  v_cvt_pk_bf16_f32 v97, v114, v115
  v_cvt_pk_bf16_f32 v98, v116, v117
  v_cvt_pk_bf16_f32 v99, v118, v119
  v_cvt_pk_bf16_f32 v100, v120, v121
  v_cvt_pk_bf16_f32 v101, v122, v123
  v_cvt_pk_bf16_f32 v102, v124, v125
  v_cvt_pk_bf16_f32 v103, v126, v127
  buffer_store_dwordx4 v[96:99], v2, s[16:19], s37 offen offset:2048 sc1
  buffer_store_dwordx4 v[100:103], v2, s[16:19], s37 offen offset:3072 sc1
  v_pk_mul_f32 v[64:65], v[64:65], v[192:193]
  v_pk_mul_f32 v[66:67], v[66:67], v[192:193]
  v_pk_mul_f32 v[68:69], v[68:69], v[192:193]
  v_pk_mul_f32 v[70:71], v[70:71], v[192:193]
  v_pk_mul_f32 v[72:73], v[72:73], v[192:193]
  v_pk_mul_f32 v[74:75], v[74:75], v[192:193]
  v_pk_mul_f32 v[76:77], v[76:77], v[192:193]
  v_pk_mul_f32 v[78:79], v[78:79], v[192:193]
  v_exp_f32 v64, v64
  v_exp_f32 v65, v65
  v_exp_f32 v66, v66
  v_exp_f32 v67, v67
  v_exp_f32 v68, v68
  v_exp_f32 v69, v69
  v_exp_f32 v70, v70
  v_exp_f32 v71, v71
  v_exp_f32 v72, v72
  v_exp_f32 v73, v73
  v_exp_f32 v74, v74
  v_exp_f32 v75, v75
  v_exp_f32 v76, v76
  v_exp_f32 v77, v77
  v_exp_f32 v78, v78
  v_exp_f32 v79, v79
  v_pk_fma_f32 v[64:65], v[64:65], v[194:195], v[194:195]
  v_pk_fma_f32 v[66:67], v[66:67], v[194:195], v[194:195]
  v_pk_fma_f32 v[68:69], v[68:69], v[194:195], v[194:195]
  v_pk_fma_f32 v[70:71], v[70:71], v[194:195], v[194:195]
  v_pk_fma_f32 v[72:73], v[72:73], v[194:195], v[194:195]
  v_pk_fma_f32 v[74:75], v[74:75], v[194:195], v[194:195]
  v_pk_fma_f32 v[76:77], v[76:77], v[194:195], v[194:195]
  v_pk_fma_f32 v[78:79], v[78:79], v[194:195], v[194:195]
  v_rcp_f32 v64, v64
  v_rcp_f32 v65, v65
  v_rcp_f32 v66, v66
  v_rcp_f32 v67, v67
  v_rcp_f32 v68, v68
  v_rcp_f32 v69, v69
  v_rcp_f32 v70, v70
  v_rcp_f32 v71, v71
  v_rcp_f32 v72, v72
  v_rcp_f32 v73, v73
  v_rcp_f32 v74, v74
  v_rcp_f32 v75, v75
  v_rcp_f32 v76, v76
  v_rcp_f32 v77, v77
  v_rcp_f32 v78, v78
  v_rcp_f32 v79, v79
  v_pk_mul_f32 v[80:81], v[80:81], v[64:65]
  v_pk_mul_f32 v[82:83], v[82:83], v[66:67]
  v_pk_mul_f32 v[84:85], v[84:85], v[68:69]
  v_pk_mul_f32 v[86:87], v[86:87], v[70:71]
  v_pk_mul_f32 v[88:89], v[88:89], v[72:73]
  v_pk_mul_f32 v[90:91], v[90:91], v[74:75]
  v_pk_mul_f32 v[92:93], v[92:93], v[76:77]
  v_pk_mul_f32 v[94:95], v[94:95], v[78:79]
  ds_write_b32 v7, v200
  v_cvt_pk_bf16_f32 v64, v80, v81
  v_cvt_pk_bf16_f32 v65, v82, v83
  v_cvt_pk_bf16_f32 v66, v84, v85
  v_cvt_pk_bf16_f32 v67, v86, v87
  v_cvt_pk_bf16_f32 v68, v88, v89
  v_cvt_pk_bf16_f32 v69, v90, v91
  v_cvt_pk_bf16_f32 v70, v92, v93
  v_cvt_pk_bf16_f32 v71, v94, v95
  buffer_store_dwordx4 v[64:67], v2, s[16:19], s37 offen offset:0 sc1
  buffer_store_dwordx4 v[68:71], v2, s[16:19], s37 offen offset:1024 sc1
  s_setprio 0
  v_add_u32 v8, 16, v7
  ds_read_b32 v5, v8
  s_waitcnt lgkmcnt(0)
  v_cmp_gt_u32 vcc, 1, v5
  s_cbranch_vccz G_F
  s_waitcnt vmcnt(0)
  s_mov_b64 exec, 1
  v_mov_b32 v5, s20
  buffer_store_dword v5, off, s[16:19], s44 sc1
  s_mov_b64 exec, -1
  s_mov_b32 s57, 0
AS_30:
  ds_read_b32 v5, v8
  s_add_u32 s57, s57, 1
  s_waitcnt lgkmcnt(0)
  v_cmp_gt_u32 vcc, 1, v5
  s_cbranch_vccz AS_30x
  s_cmp_lt_u32 s57, 320000
  s_cbranch_scc1 AS_30
AS_30x:
G_F:
  buffer_load_dwordx4 v[216:219], v2, s[16:19], s61 offen offset:0
  buffer_load_dwordx4 v[220:223], v2, s[16:19], s61 offen offset:1024
  s_add_u32 s61, s61, 2048
  s_cmp_eq_u32 s61, s60
  s_cselect_b32 s61, s59, s61
  buffer_load_dwordx4 v[224:227], v2, s[16:19], s61 offen offset:0
  buffer_load_dwordx4 v[228:231], v2, s[16:19], s61 offen offset:1024
  s_add_u32 s61, s61, 2048
  s_cmp_eq_u32 s61, s60
  s_cselect_b32 s61, s59, s61
  s_waitcnt vmcnt(4)
  s_mov_b64 exec, 1
  v_mov_b32 v5, s20
  buffer_store_dword v5, off, s[16:19], s44 sc1
  s_mov_b64 exec, -1
  buffer_load_dwordx4 v[232:235], v2, s[16:19], s61 offen offset:0
  buffer_load_dwordx4 v[236:239], v2, s[16:19], s61 offen offset:1024
  s_add_u32 s61, s61, 2048
  s_cmp_eq_u32 s61, s60
  s_cselect_b32 s61, s59, s61
  buffer_load_dwordx4 v[240:243], v2, s[16:19], s61 offen offset:0
  buffer_load_dwordx4 v[244:247], v2, s[16:19], s61 offen offset:1024
  s_add_u32 s61, s61, 2048
  s_cmp_eq_u32 s61, s60
  s_cselect_b32 s61, s59, s61
  buffer_load_dwordx4 v[248:251], v2, s[16:19], s61 offen offset:0
  buffer_load_dwordx4 v[252:255], v2, s[16:19], s61 offen offset:1024
  s_add_u32 s61, s61, 2048
  s_cmp_eq_u32 s61, s60
  s_cselect_b32 s61, s59, s61
  buffer_load_dwordx4 v[128:131], v2, s[16:19], s61 offen offset:0
  buffer_load_dwordx4 v[132:135], v2, s[16:19], s61 offen offset:1024
  s_add_u32 s61, s61, 2048
  s_cmp_eq_u32 s61, s60
  s_cselect_b32 s61, s59, s61
  buffer_load_dwordx4 v[136:139], v2, s[16:19], s61 offen offset:0
  buffer_load_dwordx4 v[140:143], v2, s[16:19], s61 offen offset:1024
  s_add_u32 s61, s61, 2048
  s_cmp_eq_u32 s61, s60
  s_cselect_b32 s61, s59, s61
  buffer_load_dwordx4 v[144:147], v2, s[16:19], s61 offen offset:0
  buffer_load_dwordx4 v[148:151], v2, s[16:19], s61 offen offset:1024
  s_add_u32 s61, s61, 2048
  s_cmp_eq_u32 s61, s60
  s_cselect_b32 s61, s59, s61
  buffer_load_dwordx4 v[152:155], v2, s[16:19], s61 offen offset:0
  buffer_load_dwordx4 v[156:159], v2, s[16:19], s61 offen offset:1024
  s_add_u32 s61, s61, 2048
  s_cmp_eq_u32 s61, s60
  s_cselect_b32 s61, s59, s61
  buffer_load_dwordx4 v[160:163], v2, s[16:19], s61 offen offset:0
  buffer_load_dwordx4 v[164:167], v2, s[16:19], s61 offen offset:1024
  s_add_u32 s61, s61, 2048
  s_cmp_eq_u32 s61, s60
  s_cselect_b32 s61, s59, s61
  buffer_load_dwordx4 v[168:171], v2, s[16:19], s61 offen offset:0
  buffer_load_dwordx4 v[172:175], v2, s[16:19], s61 offen offset:1024
  s_add_u32 s61, s61, 2048
  s_cmp_eq_u32 s61, s60
  s_cselect_b32 s61, s59, s61
  buffer_load_dwordx4 v[176:179], v2, s[16:19], s61 offen offset:0
  buffer_load_dwordx4 v[180:183], v2, s[16:19], s61 offen offset:1024
  s_add_u32 s61, s61, 2048
  s_cmp_eq_u32 s61, s60
  s_cselect_b32 s61, s59, s61
  buffer_load_dwordx4 v[184:187], v2, s[16:19], s61 offen offset:0
  buffer_load_dwordx4 v[188:191], v2, s[16:19], s61 offen offset:1024
  s_add_u32 s61, s61, 2048
  s_cmp_eq_u32 s61, s60
  s_cselect_b32 s61, s59, s61
  buffer_load_dwordx4 v[192:195], v2, s[16:19], s61 offen offset:0
  buffer_load_dwordx4 v[196:199], v2, s[16:19], s61 offen offset:1024
  s_lshr_b32 s46, s23, 4
  s_mul_i32 s46, s46, 448
  s_lshl_b32 s47, s52, 6
  s_lshl_b32 s48, s3, 4
  s_add_u32 s47, s47, s48
  s_add_u32 s46, s46, s47
  s_lshl_b32 s46, s46, 7
  s_add_u32 s46, s46, 262144
  v_and_b32 v3, 15, v0
  v_lshl_add_u32 v3, v3, 7, s46
  s_mul_i32 s46, s23, 448
  s_add_u32 s46, s46, s47
  s_lshl_b32 s46, s46, 7
  s_add_u32 s46, s46, 6291456
  s_mul_i32 s47, s3, 2080
  s_add_u32 s47, s47, 82448
  v_add_u32 v14, s47, v2
  v_mov_b32 v13, v2
  s_mul_i32 s48, s52, 16
  v_and_b32 v12, 31, v0
  v_min_u32 v12, 15, v12
  v_add_u32 v12, s48, v12
  v_min_u32 v12, 111, v12
  v_lshlrev_b32 v12, 7, v12
  v_lshrrev_b32 v11, 5, v0
  v_mul_u32_u24 v11, 114688, v11
  v_add_u32 v12, v12, v11
  v_and_b32 v15, 3, v0
  v_lshlrev_b32 v15, 2, v15
  v_add_u32 v15, 97664, v15
  s_mov_b32 s57, 0
AS_31:
  ds_read_b32 v5, v15
  s_add_u32 s57, s57, 1
  s_waitcnt lgkmcnt(0)
  v_cmp_gt_u32 vcc, 3, v5
  s_cbranch_vccz AS_31x
  s_cmp_lt_u32 s57, 320000
  s_cbranch_scc1 AS_31
AS_31x:
  s_mov_b32 s57, 0
  buffer_load_dword v5, v4, s[16:19], 0 offen sc1
  s_waitcnt vmcnt(0)
  v_cmp_ne_u32 vcc, s20, v5
  s_cbranch_vccz PD_33
PL_32:
  buffer_load_dword v5, v4, s[16:19], 0 offen sc1
  s_add_u32 s57, s57, 1
  s_waitcnt vmcnt(0)
  v_cmp_ne_u32 vcc, s20, v5
  s_cbranch_vccz PD_33
  s_cmp_lt_u32 s57, 20000
  s_cbranch_scc1 PL_32
PD_33:
G_H:
  v_mov_b32 v5, -1
  ds_write_b32 v7, v5
  s_mul_i32 s40, s23, 224
  s_mul_i32 s41, s54, 28
  s_add_u32 s40, s40, s41
  s_add_u32 s40, s40, 8192
  s_add_u32 s41, s40, 14
  s_add_u32 s42, s40, s36
  s_lshl_b32 s40, s40, 10
  s_lshl_b32 s41, s41, 10
  s_lshl_b32 s42, s42, 10
  s_lshl_b32 s43, s54, 14
  s_add_u32 s43, s43, 98304
  v_add_u32 v5, s43, v2
  buffer_load_dwordx4 v[80:83], v2, s[16:19], s42 offen
  buffer_load_dwordx4 v[84:87], v1, s[16:19], s42 offen
  s_add_u32 s42, s42, 1024
  s_cmp_eq_u32 s42, s41
  s_cselect_b32 s42, s40, s42
  buffer_load_dwordx4 v[88:91], v2, s[16:19], s42 offen
  buffer_load_dwordx4 v[92:95], v1, s[16:19], s42 offen
  s_add_u32 s42, s42, 1024
  s_cmp_eq_u32 s42, s41
  s_cselect_b32 s42, s40, s42
  buffer_load_dwordx4 v[96:99], v2, s[16:19], s42 offen
  buffer_load_dwordx4 v[100:103], v1, s[16:19], s42 offen
  s_add_u32 s42, s42, 1024
  s_cmp_eq_u32 s42, s41
  s_cselect_b32 s42, s40, s42
  buffer_load_dwordx4 v[104:107], v2, s[16:19], s42 offen
  buffer_load_dwordx4 v[108:111], v1, s[16:19], s42 offen
  s_add_u32 s42, s42, 1024
  s_cmp_eq_u32 s42, s41
  s_cselect_b32 s42, s40, s42
  buffer_load_dwordx4 v[112:115], v2, s[16:19], s42 offen
  buffer_load_dwordx4 v[116:119], v1, s[16:19], s42 offen
  s_add_u32 s42, s42, 1024
  s_cmp_eq_u32 s42, s41
  s_cselect_b32 s42, s40, s42
  buffer_load_dwordx4 v[120:123], v2, s[16:19], s42 offen
  buffer_load_dwordx4 v[124:127], v1, s[16:19], s42 offen
  s_add_u32 s42, s42, 1024
  s_cmp_eq_u32 s42, s41
  s_cselect_b32 s42, s40, s42
  buffer_load_dword v11, v12, s[16:19], s41 offen
  s_waitcnt vmcnt(11)
  v_mfma_f32_32x32x16_bf16 v[16:31], v[216:219], v[80:83], 0
  v_mfma_f32_32x32x16_bf16 v[32:47], v[220:223], v[80:83], 0
  v_mfma_f32_32x32x16_bf16 v[48:63], v[216:219], v[84:87], 0
  v_mfma_f32_32x32x16_bf16 v[64:79], v[220:223], v[84:87], 0
  buffer_load_dwordx4 v[200:203], v2, s[16:19], s42 offen
  buffer_load_dwordx4 v[204:207], v1, s[16:19], s42 offen
  s_add_u32 s42, s42, 1024
  s_cmp_eq_u32 s42, s41
  s_cselect_b32 s42, s40, s42
  s_waitcnt vmcnt(11)
  v_mfma_f32_32x32x16_bf16 v[16:31], v[224:227], v[88:91], v[16:31]
  v_mfma_f32_32x32x16_bf16 v[32:47], v[228:231], v[88:91], v[32:47]
  v_mfma_f32_32x32x16_bf16 v[48:63], v[224:227], v[92:95], v[48:63]
  v_mfma_f32_32x32x16_bf16 v[64:79], v[228:231], v[92:95], v[64:79]
  buffer_load_dwordx4 v[208:211], v2, s[16:19], s42 offen
  buffer_load_dwordx4 v[212:215], v1, s[16:19], s42 offen
  s_add_u32 s42, s42, 1024
  s_cmp_eq_u32 s42, s41
  s_cselect_b32 s42, s40, s42
  s_waitcnt vmcnt(11)
  v_mfma_f32_32x32x16_bf16 v[16:31], v[232:235], v[96:99], v[16:31]
  v_mfma_f32_32x32x16_bf16 v[32:47], v[236:239], v[96:99], v[32:47]
  v_mfma_f32_32x32x16_bf16 v[48:63], v[232:235], v[100:103], v[48:63]
  v_mfma_f32_32x32x16_bf16 v[64:79], v[236:239], v[100:103], v[64:79]
  s_add_u32 m0, s43, 0
  s_nop 0
  buffer_load_dwordx4 v2, s[16:19], s42 offen lds
  s_add_u32 m0, s43, 1024
  s_nop 0
  buffer_load_dwordx4 v1, s[16:19], s42 offen lds
  s_add_u32 s42, s42, 1024
  s_cmp_eq_u32 s42, s41
  s_cselect_b32 s42, s40, s42
  s_waitcnt vmcnt(11)
  v_mfma_f32_32x32x16_bf16 v[16:31], v[240:243], v[104:107], v[16:31]
  v_mfma_f32_32x32x16_bf16 v[32:47], v[244:247], v[104:107], v[32:47]
  v_mfma_f32_32x32x16_bf16 v[48:63], v[240:243], v[108:111], v[48:63]
  v_mfma_f32_32x32x16_bf16 v[64:79], v[244:247], v[108:111], v[64:79]
  s_add_u32 m0, s43, 2048
  s_nop 0
  buffer_load_dwordx4 v2, s[16:19], s42 offen lds
  s_add_u32 m0, s43, 3072
  s_nop 0
  buffer_load_dwordx4 v1, s[16:19], s42 offen lds
  s_add_u32 s42, s42, 1024
  s_cmp_eq_u32 s42, s41
  s_cselect_b32 s42, s40, s42
  s_waitcnt vmcnt(11)
  v_mfma_f32_32x32x16_bf16 v[16:31], v[248:251], v[112:115], v[16:31]
  v_mfma_f32_32x32x16_bf16 v[32:47], v[252:255], v[112:115], v[32:47]
  v_mfma_f32_32x32x16_bf16 v[48:63], v[248:251], v[116:119], v[48:63]
  v_mfma_f32_32x32x16_bf16 v[64:79], v[252:255], v[116:119], v[64:79]
  s_add_u32 m0, s43, 4096
  s_nop 0
  buffer_load_dwordx4 v2, s[16:19], s42 offen lds
  s_add_u32 m0, s43, 5120
  s_nop 0
  buffer_load_dwordx4 v1, s[16:19], s42 offen lds
  s_add_u32 s42, s42, 1024
  s_cmp_eq_u32 s42, s41
  s_cselect_b32 s42, s40, s42
  s_waitcnt vmcnt(11)
  v_mfma_f32_32x32x16_bf16 v[16:31], v[128:131], v[120:123], v[16:31]
  v_mfma_f32_32x32x16_bf16 v[32:47], v[132:135], v[120:123], v[32:47]
  v_mfma_f32_32x32x16_bf16 v[48:63], v[128:131], v[124:127], v[48:63]
  v_mfma_f32_32x32x16_bf16 v[64:79], v[132:135], v[124:127], v[64:79]
  s_mov_b32 s24, s4
  s_and_b32 s25, s5, 0xffff
  s_mov_b32 s26, 1835008
  s_mov_b32 s27, 0x20000
  s_mov_b32 s28, s14
  s_and_b32 s29, s15, 0xffff
  s_mov_b32 s30, 1835008
  s_mov_b32 s31, 0x20000
  v_lshrrev_b32 v242, 3, v0
  v_and_b32 v243, 7, v0
  s_lshl_b32 s38, s3, 3
  s_lshl_b32 s39, s23, 6
  s_add_u32 s39, s39, s38
  s_mul_i32 s39, s39, 896
  s_lshl_b32 s47, s52, 7
  s_add_u32 s39, s39, s47
  v_mul_u32_u24 v236, 896, v242
  v_lshl_add_u32 v236, v243, 4, v236
  buffer_load_dwordx4 v[232:235], v236, s[24:27], s39 offen
  v_and_b32 v225, 31, v0
  v_lshrrev_b32 v224, 5, v0
  v_and_b32 v226, 1, v0
  v_xor_b32 v224, v224, v243
  v_lshl_or_b32 v224, v226, 3, v224
  v_lshlrev_b32 v224, 4, v224
  v_lshl_or_b32 v224, v225, 8, v224
  v_add_u32 v224, s43, v224
  v_xor_b32 v225, 32, v224
  v_xor_b32 v226, 64, v224
  v_xor_b32 v227, 96, v224
  v_xor_b32 v228, 128, v224
  v_xor_b32 v229, 160, v224
  v_xor_b32 v230, 192, v224
  v_xor_b32 v231, 224, v224
  v_and_b32 v237, 1, v242
  v_lshl_or_b32 v237, v237, 3, v242
  v_xor_b32 v237, v237, v243
  v_lshlrev_b32 v237, 4, v237
  v_add_u32 v242, s38, v242
  v_lshl_or_b32 v237, v242, 8, v237
  v_xor_b32 v238, 128, v237
  v_add_u32 v239, 98304, v237
  v_add_u32 v240, 98304, v238
  v_mul_u32_u24 v241, 1040, v243
  v_lshl_add_u32 v241, v242, 1, v241
  v_add_u32 v241, 82448, v241
  v_mov_b32 v242, 0xbfb8aa3b
  v_mov_b32 v243, 0xbfb8aa3b
  v_mov_b32 v244, 0
  v_mov_b32 v245, 0
  v_mov_b32 v246, 0
  v_mov_b32 v247, 0
  v_mov_b32 v248, 0
  v_mov_b32 v249, 0
  v_mov_b32 v250, 0
  v_mov_b32 v251, 0
  s_add_u32 m0, s43, 6144
  s_nop 0
  buffer_load_dwordx4 v2, s[16:19], s42 offen lds
  s_add_u32 m0, s43, 7168
  s_nop 0
  buffer_load_dwordx4 v1, s[16:19], s42 offen lds
  s_add_u32 s42, s42, 1024
  s_cmp_eq_u32 s42, s41
  s_cselect_b32 s42, s40, s42
  s_waitcnt vmcnt(11)
  v_mfma_f32_32x32x16_bf16 v[16:31], v[136:139], v[200:203], v[16:31]
  v_mfma_f32_32x32x16_bf16 v[32:47], v[140:143], v[200:203], v[32:47]
  v_mfma_f32_32x32x16_bf16 v[48:63], v[136:139], v[204:207], v[48:63]
  v_mfma_f32_32x32x16_bf16 v[64:79], v[140:143], v[204:207], v[64:79]
  s_add_u32 m0, s43, 8192
  s_nop 0
  buffer_load_dwordx4 v2, s[16:19], s42 offen lds
  s_add_u32 m0, s43, 9216
  s_nop 0
  buffer_load_dwordx4 v1, s[16:19], s42 offen lds
  s_add_u32 s42, s42, 1024
  s_cmp_eq_u32 s42, s41
  s_cselect_b32 s42, s40, s42
  s_waitcnt vmcnt(11)
  s_waitcnt vmcnt(9)
  ds_read_b128 v[80:83], v5 offset:0
  ds_read_b128 v[84:87], v5 offset:1024
  v_mfma_f32_32x32x16_bf16 v[16:31], v[144:147], v[208:211], v[16:31]
  v_mfma_f32_32x32x16_bf16 v[32:47], v[148:151], v[208:211], v[32:47]
  v_mfma_f32_32x32x16_bf16 v[48:63], v[144:147], v[212:215], v[48:63]
  v_mfma_f32_32x32x16_bf16 v[64:79], v[148:151], v[212:215], v[64:79]
  s_add_u32 m0, s43, 10240
  s_nop 0
  buffer_load_dwordx4 v2, s[16:19], s42 offen lds
  s_add_u32 m0, s43, 11264
  s_nop 0
  buffer_load_dwordx4 v1, s[16:19], s42 offen lds
  s_waitcnt lgkmcnt(0)
  s_waitcnt vmcnt(9)
  ds_read_b128 v[88:91], v5 offset:2048
  ds_read_b128 v[92:95], v5 offset:3072
  v_mfma_f32_32x32x16_bf16 v[16:31], v[152:155], v[80:83], v[16:31]
  v_mfma_f32_32x32x16_bf16 v[32:47], v[156:159], v[80:83], v[32:47]
  v_mfma_f32_32x32x16_bf16 v[48:63], v[152:155], v[84:87], v[48:63]
  v_mfma_f32_32x32x16_bf16 v[64:79], v[156:159], v[84:87], v[64:79]
  s_waitcnt lgkmcnt(0)
  s_waitcnt vmcnt(7)
  ds_read_b128 v[96:99], v5 offset:4096
  ds_read_b128 v[100:103], v5 offset:5120
  v_mfma_f32_32x32x16_bf16 v[16:31], v[160:163], v[88:91], v[16:31]
  v_mfma_f32_32x32x16_bf16 v[32:47], v[164:167], v[88:91], v[32:47]
  v_mfma_f32_32x32x16_bf16 v[48:63], v[160:163], v[92:95], v[48:63]
  v_mfma_f32_32x32x16_bf16 v[64:79], v[164:167], v[92:95], v[64:79]
  s_waitcnt lgkmcnt(0)
  s_waitcnt vmcnt(4)
  ds_read_b128 v[104:107], v5 offset:6144
  ds_read_b128 v[108:111], v5 offset:7168
  v_mfma_f32_32x32x16_bf16 v[16:31], v[168:171], v[96:99], v[16:31]
  v_mfma_f32_32x32x16_bf16 v[32:47], v[172:175], v[96:99], v[32:47]
  v_mfma_f32_32x32x16_bf16 v[48:63], v[168:171], v[100:103], v[48:63]
  v_mfma_f32_32x32x16_bf16 v[64:79], v[172:175], v[100:103], v[64:79]
  s_waitcnt lgkmcnt(0)
  s_waitcnt vmcnt(2)
  ds_read_b128 v[112:115], v5 offset:8192
  ds_read_b128 v[116:119], v5 offset:9216
  v_mfma_f32_32x32x16_bf16 v[16:31], v[176:179], v[104:107], v[16:31]
  v_mfma_f32_32x32x16_bf16 v[32:47], v[180:183], v[104:107], v[32:47]
  v_mfma_f32_32x32x16_bf16 v[48:63], v[176:179], v[108:111], v[48:63]
  v_mfma_f32_32x32x16_bf16 v[64:79], v[180:183], v[108:111], v[64:79]
  s_waitcnt lgkmcnt(0)
  s_waitcnt vmcnt(0)
  ds_read_b128 v[120:123], v5 offset:10240
  ds_read_b128 v[124:127], v5 offset:11264
  v_mfma_f32_32x32x16_bf16 v[16:31], v[184:187], v[112:115], v[16:31]
  v_mfma_f32_32x32x16_bf16 v[32:47], v[188:191], v[112:115], v[32:47]
  v_mfma_f32_32x32x16_bf16 v[48:63], v[184:187], v[116:119], v[48:63]
  v_mfma_f32_32x32x16_bf16 v[64:79], v[188:191], v[116:119], v[64:79]
  s_waitcnt lgkmcnt(0)
  v_mfma_f32_32x32x16_bf16 v[16:31], v[192:195], v[120:123], v[16:31]
  v_mfma_f32_32x32x16_bf16 v[32:47], v[196:199], v[120:123], v[32:47]
  v_mfma_f32_32x32x16_bf16 v[48:63], v[192:195], v[124:127], v[48:63]
  v_mfma_f32_32x32x16_bf16 v[64:79], v[196:199], v[124:127], v[64:79]
  buffer_load_dword v4, v3, s[16:19], 0 offen sc1
  s_nop 7
  ds_write_b128 v224, v[16:19] offset:0
  ds_write_b128 v225, v[20:23] offset:0
  ds_write_b128 v226, v[24:27] offset:0
  ds_write_b128 v227, v[28:31] offset:0
  ds_write_b128 v228, v[32:35] offset:0
  ds_write_b128 v229, v[36:39] offset:0
  ds_write_b128 v230, v[40:43] offset:0
  ds_write_b128 v231, v[44:47] offset:0
  ds_write_b128 v224, v[48:51] offset:8192
  ds_write_b128 v225, v[52:55] offset:8192
  ds_write_b128 v226, v[56:59] offset:8192
  ds_write_b128 v227, v[60:63] offset:8192
  ds_write_b128 v228, v[64:67] offset:8192
  ds_write_b128 v229, v[68:71] offset:8192
  ds_write_b128 v230, v[72:75] offset:8192
  ds_write_b128 v231, v[76:79] offset:8192
  s_lshl_b32 s40, s3, 2
  s_add_u32 s40, s40, 97696
  v_mov_b32 v6, s40
  v_add_u32 v15, 32, v15
  s_waitcnt lgkmcnt(0)
  ds_write_b32 v6, v6
  s_mov_b32 s57, 0
  s_waitcnt vmcnt(0)
  v_cmp_ne_u32 vcc, s20, v4
  s_cbranch_vccz PD_35
PL_34:
  buffer_load_dword v4, v3, s[16:19], 0 offen sc1
  s_add_u32 s57, s57, 1
  s_waitcnt vmcnt(0)
  v_cmp_ne_u32 vcc, s20, v4
  s_cbranch_vccz PD_35
  s_cmp_lt_u32 s57, 20000
  s_cbranch_scc1 PL_34
PD_35:
  buffer_load_dwordx4 v[84:87], v13, s[16:19], s46 offen sc1
  buffer_load_dwordx4 v[88:91], v13, s[16:19], s46 offen offset:1024 sc1
  s_mov_b32 s57, 0
AS_36:
  ds_read_b32 v6, v15
  s_add_u32 s57, s57, 1
  s_waitcnt lgkmcnt(0)
  v_cmp_gt_u32 vcc, 1, v6
  s_cbranch_vccz AS_36x
  s_cmp_lt_u32 s57, 320000
  s_cbranch_scc1 AS_36
AS_36x:
  ds_read_b128 v[96:99], v239 offset:0
  ds_read_b128 v[100:103], v240 offset:0
  ds_read_b128 v[104:107], v239 offset:8192
  ds_read_b128 v[108:111], v240 offset:8192
  ds_read_b128 v[112:115], v239 offset:16384
  ds_read_b128 v[116:119], v240 offset:16384
  ds_read_b128 v[120:123], v239 offset:24576
  ds_read_b128 v[124:127], v240 offset:24576
  ds_read_b128 v[128:131], v239 offset:32768
  ds_read_b128 v[132:135], v240 offset:32768
  ds_read_b128 v[136:139], v239 offset:40960
  ds_read_b128 v[140:143], v240 offset:40960
  ds_read_b128 v[144:147], v239 offset:49152
  ds_read_b128 v[148:151], v240 offset:49152
  ds_read_b128 v[152:155], v239 offset:57344
  ds_read_b128 v[156:159], v240 offset:57344
  s_waitcnt lgkmcnt(8)
  v_pk_add_f32 v[96:97], v[96:97], v[112:113]
  v_pk_add_f32 v[98:99], v[98:99], v[114:115]
  v_pk_add_f32 v[100:101], v[100:101], v[116:117]
  v_pk_add_f32 v[102:103], v[102:103], v[118:119]
  v_pk_add_f32 v[104:105], v[104:105], v[120:121]
  v_pk_add_f32 v[106:107], v[106:107], v[122:123]
  v_pk_add_f32 v[108:109], v[108:109], v[124:125]
  v_pk_add_f32 v[110:111], v[110:111], v[126:127]
  s_waitcnt lgkmcnt(4)
  v_pk_add_f32 v[96:97], v[96:97], v[128:129]
  v_pk_add_f32 v[98:99], v[98:99], v[130:131]
  v_pk_add_f32 v[100:101], v[100:101], v[132:133]
  v_pk_add_f32 v[102:103], v[102:103], v[134:135]
  v_pk_add_f32 v[104:105], v[104:105], v[136:137]
  v_pk_add_f32 v[106:107], v[106:107], v[138:139]
  v_pk_add_f32 v[108:109], v[108:109], v[140:141]
  v_pk_add_f32 v[110:111], v[110:111], v[142:143]
  s_waitcnt lgkmcnt(0)
  v_pk_add_f32 v[96:97], v[96:97], v[144:145]
  v_pk_add_f32 v[98:99], v[98:99], v[146:147]
  v_pk_add_f32 v[100:101], v[100:101], v[148:149]
  v_pk_add_f32 v[102:103], v[102:103], v[150:151]
  v_pk_add_f32 v[104:105], v[104:105], v[152:153]
  v_pk_add_f32 v[106:107], v[106:107], v[154:155]
  v_pk_add_f32 v[108:109], v[108:109], v[156:157]
  v_pk_add_f32 v[110:111], v[110:111], v[158:159]
  ds_write_b128 v239, v[96:99] offset:0
  ds_write_b128 v240, v[100:103] offset:0
  ds_write_b128 v239, v[104:107] offset:8192
  ds_write_b128 v240, v[108:111] offset:8192
  s_waitcnt vmcnt(1)
  ds_write_b128 v14, v[84:87]
  s_waitcnt vmcnt(0)
  ds_write_b128 v14, v[88:91] offset:1040
  s_branch FINAL
SV:
  s_lshl_b32 s21, s21, 2
  s_add_u32 s21, s21, s22
  v_lshrrev_b32 v1, 3, v0
  v_and_b32 v2, 7, v0
  v_mul_u32_u24 v3, 896, v1
  v_lshl_add_u32 v4, v2, 4, v3
  s_lshl_b32 s23, s21, 3
  s_add_u32 s23, s23, s3
  s_mul_i32 s36, s23, 7168
  s_lshl_b32 s37, s3, 5
  s_add_u32 s37, s37, s21
  s_waitcnt lgkmcnt(0)
  s_load_dword s20, s[6:7], 0
  s_mov_b32 s24, s4
  s_and_b32 s25, s5, 0xffff
  s_mov_b32 s26, 1835008
  s_mov_b32 s27, 0x20000
  buffer_load_dwordx4 v[16:19], v4, s[24:27], s36 offen offset:0
  buffer_load_dwordx4 v[20:23], v4, s[24:27], s36 offen offset:128
  buffer_load_dwordx4 v[24:27], v4, s[24:27], s36 offen offset:256
  buffer_load_dwordx4 v[28:31], v4, s[24:27], s36 offen offset:384
  buffer_load_dwordx4 v[32:35], v4, s[24:27], s36 offen offset:512
  buffer_load_dwordx4 v[36:39], v4, s[24:27], s36 offen offset:640
  buffer_load_dwordx4 v[40:43], v4, s[24:27], s36 offen offset:768
  s_mov_b32 s16, s6
  s_and_b32 s17, s7, 0xffff
  s_mov_b32 s18, 16777216
  s_mov_b32 s19, 0x20000
  v_bfe_u32 v6, v0, 2, 2
  v_bfe_u32 v8, v0, 4, 1
  v_and_b32 v9, 3, v0
  v_lshl_or_b32 v8, v8, 2, v9
  v_mul_u32_u24 v8, 7696, v8
  v_mul_u32_u24 v6, 960, v6
  v_add_u32 v8, v8, v6
  v_lshrrev_b32 v7, 5, v0
  v_lshl_add_u32 v8, v7, 3, v8
  s_mul_i32 s42, s3, 112
  s_add_u32 s42, s42, 65536
  v_add_u32 v14, s42, v8
  v_mul_u32_u24 v15, 960, v1
  v_lshl_add_u32 v15, v2, 4, v15
  s_mul_i32 s42, s3, 7696
  s_add_u32 s42, s42, 65536
  v_add_u32 v15, s42, v15
  v_mov_b32 v6, 0
  v_mov_b32 v7, 0
  s_mov_b32 s42, 0x3f803f80
  s_waitcnt lgkmcnt(0)
  s_mul_i32 s20, s20, 0x9e3779b1
  s_add_u32 s20, s20, 0x7f4a7c15
  s_waitcnt vmcnt(6)
  v_dot2_f32_bf16 v6, v16, s42, v6
  v_dot2_f32_bf16 v7, v16, v16, v7
  v_dot2_f32_bf16 v6, v17, s42, v6
  v_dot2_f32_bf16 v7, v17, v17, v7
  v_dot2_f32_bf16 v6, v18, s42, v6
  v_dot2_f32_bf16 v7, v18, v18, v7
  v_dot2_f32_bf16 v6, v19, s42, v6
  v_dot2_f32_bf16 v7, v19, v19, v7
  s_waitcnt vmcnt(5)
  v_dot2_f32_bf16 v6, v20, s42, v6
  v_dot2_f32_bf16 v7, v20, v20, v7
  v_dot2_f32_bf16 v6, v21, s42, v6
  v_dot2_f32_bf16 v7, v21, v21, v7
  v_dot2_f32_bf16 v6, v22, s42, v6
  v_dot2_f32_bf16 v7, v22, v22, v7
  v_dot2_f32_bf16 v6, v23, s42, v6
  v_dot2_f32_bf16 v7, v23, v23, v7
  s_waitcnt vmcnt(4)
  v_dot2_f32_bf16 v6, v24, s42, v6
  v_dot2_f32_bf16 v7, v24, v24, v7
  v_dot2_f32_bf16 v6, v25, s42, v6
  v_dot2_f32_bf16 v7, v25, v25, v7
  v_dot2_f32_bf16 v6, v26, s42, v6
  v_dot2_f32_bf16 v7, v26, v26, v7
  v_dot2_f32_bf16 v6, v27, s42, v6
  v_dot2_f32_bf16 v7, v27, v27, v7
  s_waitcnt vmcnt(3)
  v_dot2_f32_bf16 v6, v28, s42, v6
  v_dot2_f32_bf16 v7, v28, v28, v7
  v_dot2_f32_bf16 v6, v29, s42, v6
  v_dot2_f32_bf16 v7, v29, v29, v7
  v_dot2_f32_bf16 v6, v30, s42, v6
  v_dot2_f32_bf16 v7, v30, v30, v7
  v_dot2_f32_bf16 v6, v31, s42, v6
  v_dot2_f32_bf16 v7, v31, v31, v7
  s_waitcnt vmcnt(2)
  v_dot2_f32_bf16 v6, v32, s42, v6
  v_dot2_f32_bf16 v7, v32, v32, v7
  v_dot2_f32_bf16 v6, v33, s42, v6
  v_dot2_f32_bf16 v7, v33, v33, v7
  v_dot2_f32_bf16 v6, v34, s42, v6
  v_dot2_f32_bf16 v7, v34, v34, v7
  v_dot2_f32_bf16 v6, v35, s42, v6
  v_dot2_f32_bf16 v7, v35, v35, v7
  s_waitcnt vmcnt(1)
  v_dot2_f32_bf16 v6, v36, s42, v6
  v_dot2_f32_bf16 v7, v36, v36, v7
  v_dot2_f32_bf16 v6, v37, s42, v6
  v_dot2_f32_bf16 v7, v37, v37, v7
  v_dot2_f32_bf16 v6, v38, s42, v6
  v_dot2_f32_bf16 v7, v38, v38, v7
  v_dot2_f32_bf16 v6, v39, s42, v6
  v_dot2_f32_bf16 v7, v39, v39, v7
  s_waitcnt vmcnt(0)
  v_dot2_f32_bf16 v6, v40, s42, v6
  v_dot2_f32_bf16 v7, v40, v40, v7
  v_dot2_f32_bf16 v6, v41, s42, v6
  v_dot2_f32_bf16 v7, v41, v41, v7
  v_dot2_f32_bf16 v6, v42, s42, v6
  v_dot2_f32_bf16 v7, v42, v42, v7
  v_dot2_f32_bf16 v6, v43, s42, v6
  v_dot2_f32_bf16 v7, v43, v43, v7
  s_nop 1
  v_add_f32_dpp v6, v6, v6 quad_perm:[1,0,3,2] row_mask:0xf bank_mask:0xf
  v_add_f32_dpp v7, v7, v7 quad_perm:[1,0,3,2] row_mask:0xf bank_mask:0xf
  s_nop 0
  v_add_f32_dpp v6, v6, v6 quad_perm:[2,3,0,1] row_mask:0xf bank_mask:0xf
  v_add_f32_dpp v7, v7, v7 quad_perm:[2,3,0,1] row_mask:0xf bank_mask:0xf
  s_nop 0
  v_add_f32_dpp v6, v6, v6 row_half_mirror row_mask:0xf bank_mask:0xf
  v_add_f32_dpp v7, v7, v7 row_half_mirror row_mask:0xf bank_mask:0xf
  v_mul_f32 v6, 0xbb124925, v6
  v_mul_f32 v7, 0x3b124925, v7
  v_fma_f32 v7, -v6, v6, v7
  v_max_f32 v7, 0, v7
  v_cvt_pk_bf16_f32 v8, v6, v6
  v_and_b32 v6, 0xffff0000, v8
  v_cvt_pk_bf16_f32 v7, v7, v7
  v_and_b32 v7, 0xffff0000, v7
  v_add_f32 v7, 0x3727c5ac, v7
  v_cvt_pk_bf16_f32 v7, v7, v7
  v_and_b32 v7, 0xffff0000, v7
  v_sqrt_f32 v7, v7
  s_nop 0
  v_cvt_pk_bf16_f32 v10, v7, v7
  v_and_b32 v10, 0xffff0000, v10
  v_rcp_f32 v7, v10
  v_mov_b32 v11, s20
  v_mov_b32 v60, v7
  v_lshlrev_b32 v3, 4, v1
  v_mul_f32 v9, 0xbfb8aa3b, v7
  s_lshl_b32 s42, s23, 7
  s_add_u32 s42, s42, 1048576
  v_cmp_eq_u32 vcc, 0, v2
  s_mov_b64 exec, vcc
  buffer_store_dwordx4 v[8:11], v3, s[16:19], s42 offen sc1
  s_mov_b64 exec, -1
  v_lshlrev_b32 v44, 16, v16
  v_and_b32 v45, 0xffff0000, v16
  v_lshlrev_b32 v46, 16, v17
  v_and_b32 v47, 0xffff0000, v17
  v_lshlrev_b32 v48, 16, v18
  v_and_b32 v49, 0xffff0000, v18
  v_lshlrev_b32 v50, 16, v19
  v_and_b32 v51, 0xffff0000, v19
  v_pk_add_f32 v[44:45], v[44:45], v[6:7] op_sel_hi:[1,0]
  v_pk_add_f32 v[46:47], v[46:47], v[6:7] op_sel_hi:[1,0]
  v_pk_add_f32 v[48:49], v[48:49], v[6:7] op_sel_hi:[1,0]
  v_pk_add_f32 v[50:51], v[50:51], v[6:7] op_sel_hi:[1,0]
  v_cvt_pk_bf16_f32 v16, v44, v45
  v_cvt_pk_bf16_f32 v17, v46, v47
  v_cvt_pk_bf16_f32 v18, v48, v49
  v_cvt_pk_bf16_f32 v19, v50, v51
  v_lshlrev_b32 v44, 16, v16
  v_and_b32 v45, 0xffff0000, v16
  v_lshlrev_b32 v46, 16, v17
  v_and_b32 v47, 0xffff0000, v17
  v_lshlrev_b32 v48, 16, v18
  v_and_b32 v49, 0xffff0000, v18
  v_lshlrev_b32 v50, 16, v19
  v_and_b32 v51, 0xffff0000, v19
  v_pk_mul_f32 v[44:45], v[44:45], v[60:61] op_sel_hi:[1,0]
  v_pk_mul_f32 v[46:47], v[46:47], v[60:61] op_sel_hi:[1,0]
  v_pk_mul_f32 v[48:49], v[48:49], v[60:61] op_sel_hi:[1,0]
  v_pk_mul_f32 v[50:51], v[50:51], v[60:61] op_sel_hi:[1,0]
  v_cvt_pk_bf16_f32 v16, v44, v45
  v_cvt_pk_bf16_f32 v17, v46, v47
  v_cvt_pk_bf16_f32 v18, v48, v49
  v_cvt_pk_bf16_f32 v19, v50, v51
  ds_write_b128 v15, v[16:19] offset:0
  v_lshlrev_b32 v52, 16, v20
  v_and_b32 v53, 0xffff0000, v20
  v_lshlrev_b32 v54, 16, v21
  v_and_b32 v55, 0xffff0000, v21
  v_lshlrev_b32 v56, 16, v22
  v_and_b32 v57, 0xffff0000, v22
  v_lshlrev_b32 v58, 16, v23
  v_and_b32 v59, 0xffff0000, v23
  v_pk_add_f32 v[52:53], v[52:53], v[6:7] op_sel_hi:[1,0]
  v_pk_add_f32 v[54:55], v[54:55], v[6:7] op_sel_hi:[1,0]
  v_pk_add_f32 v[56:57], v[56:57], v[6:7] op_sel_hi:[1,0]
  v_pk_add_f32 v[58:59], v[58:59], v[6:7] op_sel_hi:[1,0]
  v_cvt_pk_bf16_f32 v20, v52, v53
  v_cvt_pk_bf16_f32 v21, v54, v55
  v_cvt_pk_bf16_f32 v22, v56, v57
  v_cvt_pk_bf16_f32 v23, v58, v59
  v_lshlrev_b32 v52, 16, v20
  v_and_b32 v53, 0xffff0000, v20
  v_lshlrev_b32 v54, 16, v21
  v_and_b32 v55, 0xffff0000, v21
  v_lshlrev_b32 v56, 16, v22
  v_and_b32 v57, 0xffff0000, v22
  v_lshlrev_b32 v58, 16, v23
  v_and_b32 v59, 0xffff0000, v23
  v_pk_mul_f32 v[52:53], v[52:53], v[60:61] op_sel_hi:[1,0]
  v_pk_mul_f32 v[54:55], v[54:55], v[60:61] op_sel_hi:[1,0]
  v_pk_mul_f32 v[56:57], v[56:57], v[60:61] op_sel_hi:[1,0]
  v_pk_mul_f32 v[58:59], v[58:59], v[60:61] op_sel_hi:[1,0]
  v_cvt_pk_bf16_f32 v20, v52, v53
  v_cvt_pk_bf16_f32 v21, v54, v55
  v_cvt_pk_bf16_f32 v22, v56, v57
  v_cvt_pk_bf16_f32 v23, v58, v59
  ds_write_b128 v15, v[20:23] offset:128
  v_lshlrev_b32 v44, 16, v24
  v_and_b32 v45, 0xffff0000, v24
  v_lshlrev_b32 v46, 16, v25
  v_and_b32 v47, 0xffff0000, v25
  v_lshlrev_b32 v48, 16, v26
  v_and_b32 v49, 0xffff0000, v26
  v_lshlrev_b32 v50, 16, v27
  v_and_b32 v51, 0xffff0000, v27
  v_pk_add_f32 v[44:45], v[44:45], v[6:7] op_sel_hi:[1,0]
  v_pk_add_f32 v[46:47], v[46:47], v[6:7] op_sel_hi:[1,0]
  v_pk_add_f32 v[48:49], v[48:49], v[6:7] op_sel_hi:[1,0]
  v_pk_add_f32 v[50:51], v[50:51], v[6:7] op_sel_hi:[1,0]
  v_cvt_pk_bf16_f32 v24, v44, v45
  v_cvt_pk_bf16_f32 v25, v46, v47
  v_cvt_pk_bf16_f32 v26, v48, v49
  v_cvt_pk_bf16_f32 v27, v50, v51
  v_lshlrev_b32 v44, 16, v24
  v_and_b32 v45, 0xffff0000, v24
  v_lshlrev_b32 v46, 16, v25
  v_and_b32 v47, 0xffff0000, v25
  v_lshlrev_b32 v48, 16, v26
  v_and_b32 v49, 0xffff0000, v26
  v_lshlrev_b32 v50, 16, v27
  v_and_b32 v51, 0xffff0000, v27
  v_pk_mul_f32 v[44:45], v[44:45], v[60:61] op_sel_hi:[1,0]
  v_pk_mul_f32 v[46:47], v[46:47], v[60:61] op_sel_hi:[1,0]
  v_pk_mul_f32 v[48:49], v[48:49], v[60:61] op_sel_hi:[1,0]
  v_pk_mul_f32 v[50:51], v[50:51], v[60:61] op_sel_hi:[1,0]
  v_cvt_pk_bf16_f32 v24, v44, v45
  v_cvt_pk_bf16_f32 v25, v46, v47
  v_cvt_pk_bf16_f32 v26, v48, v49
  v_cvt_pk_bf16_f32 v27, v50, v51
  ds_write_b128 v15, v[24:27] offset:256
  v_lshlrev_b32 v52, 16, v28
  v_and_b32 v53, 0xffff0000, v28
  v_lshlrev_b32 v54, 16, v29
  v_and_b32 v55, 0xffff0000, v29
  v_lshlrev_b32 v56, 16, v30
  v_and_b32 v57, 0xffff0000, v30
  v_lshlrev_b32 v58, 16, v31
  v_and_b32 v59, 0xffff0000, v31
  v_pk_add_f32 v[52:53], v[52:53], v[6:7] op_sel_hi:[1,0]
  v_pk_add_f32 v[54:55], v[54:55], v[6:7] op_sel_hi:[1,0]
  v_pk_add_f32 v[56:57], v[56:57], v[6:7] op_sel_hi:[1,0]
  v_pk_add_f32 v[58:59], v[58:59], v[6:7] op_sel_hi:[1,0]
  v_cvt_pk_bf16_f32 v28, v52, v53
  v_cvt_pk_bf16_f32 v29, v54, v55
  v_cvt_pk_bf16_f32 v30, v56, v57
  v_cvt_pk_bf16_f32 v31, v58, v59
  v_lshlrev_b32 v52, 16, v28
  v_and_b32 v53, 0xffff0000, v28
  v_lshlrev_b32 v54, 16, v29
  v_and_b32 v55, 0xffff0000, v29
  v_lshlrev_b32 v56, 16, v30
  v_and_b32 v57, 0xffff0000, v30
  v_lshlrev_b32 v58, 16, v31
  v_and_b32 v59, 0xffff0000, v31
  v_pk_mul_f32 v[52:53], v[52:53], v[60:61] op_sel_hi:[1,0]
  v_pk_mul_f32 v[54:55], v[54:55], v[60:61] op_sel_hi:[1,0]
  v_pk_mul_f32 v[56:57], v[56:57], v[60:61] op_sel_hi:[1,0]
  v_pk_mul_f32 v[58:59], v[58:59], v[60:61] op_sel_hi:[1,0]
  v_cvt_pk_bf16_f32 v28, v52, v53
  v_cvt_pk_bf16_f32 v29, v54, v55
  v_cvt_pk_bf16_f32 v30, v56, v57
  v_cvt_pk_bf16_f32 v31, v58, v59
  ds_write_b128 v15, v[28:31] offset:384
  v_lshlrev_b32 v44, 16, v32
  v_and_b32 v45, 0xffff0000, v32
  v_lshlrev_b32 v46, 16, v33
  v_and_b32 v47, 0xffff0000, v33
  v_lshlrev_b32 v48, 16, v34
  v_and_b32 v49, 0xffff0000, v34
  v_lshlrev_b32 v50, 16, v35
  v_and_b32 v51, 0xffff0000, v35
  v_pk_add_f32 v[44:45], v[44:45], v[6:7] op_sel_hi:[1,0]
  v_pk_add_f32 v[46:47], v[46:47], v[6:7] op_sel_hi:[1,0]
  v_pk_add_f32 v[48:49], v[48:49], v[6:7] op_sel_hi:[1,0]
  v_pk_add_f32 v[50:51], v[50:51], v[6:7] op_sel_hi:[1,0]
  v_cvt_pk_bf16_f32 v32, v44, v45
  v_cvt_pk_bf16_f32 v33, v46, v47
  v_cvt_pk_bf16_f32 v34, v48, v49
  v_cvt_pk_bf16_f32 v35, v50, v51
  v_lshlrev_b32 v44, 16, v32
  v_and_b32 v45, 0xffff0000, v32
  v_lshlrev_b32 v46, 16, v33
  v_and_b32 v47, 0xffff0000, v33
  v_lshlrev_b32 v48, 16, v34
  v_and_b32 v49, 0xffff0000, v34
  v_lshlrev_b32 v50, 16, v35
  v_and_b32 v51, 0xffff0000, v35
  v_pk_mul_f32 v[44:45], v[44:45], v[60:61] op_sel_hi:[1,0]
  v_pk_mul_f32 v[46:47], v[46:47], v[60:61] op_sel_hi:[1,0]
  v_pk_mul_f32 v[48:49], v[48:49], v[60:61] op_sel_hi:[1,0]
  v_pk_mul_f32 v[50:51], v[50:51], v[60:61] op_sel_hi:[1,0]
  v_cvt_pk_bf16_f32 v32, v44, v45
  v_cvt_pk_bf16_f32 v33, v46, v47
  v_cvt_pk_bf16_f32 v34, v48, v49
  v_cvt_pk_bf16_f32 v35, v50, v51
  ds_write_b128 v15, v[32:35] offset:512
  v_lshlrev_b32 v52, 16, v36
  v_and_b32 v53, 0xffff0000, v36
  v_lshlrev_b32 v54, 16, v37
  v_and_b32 v55, 0xffff0000, v37
  v_lshlrev_b32 v56, 16, v38
  v_and_b32 v57, 0xffff0000, v38
  v_lshlrev_b32 v58, 16, v39
  v_and_b32 v59, 0xffff0000, v39
  v_pk_add_f32 v[52:53], v[52:53], v[6:7] op_sel_hi:[1,0]
  v_pk_add_f32 v[54:55], v[54:55], v[6:7] op_sel_hi:[1,0]
  v_pk_add_f32 v[56:57], v[56:57], v[6:7] op_sel_hi:[1,0]
  v_pk_add_f32 v[58:59], v[58:59], v[6:7] op_sel_hi:[1,0]
  v_cvt_pk_bf16_f32 v36, v52, v53
  v_cvt_pk_bf16_f32 v37, v54, v55
  v_cvt_pk_bf16_f32 v38, v56, v57
  v_cvt_pk_bf16_f32 v39, v58, v59
  v_lshlrev_b32 v52, 16, v36
  v_and_b32 v53, 0xffff0000, v36
  v_lshlrev_b32 v54, 16, v37
  v_and_b32 v55, 0xffff0000, v37
  v_lshlrev_b32 v56, 16, v38
  v_and_b32 v57, 0xffff0000, v38
  v_lshlrev_b32 v58, 16, v39
  v_and_b32 v59, 0xffff0000, v39
  v_pk_mul_f32 v[52:53], v[52:53], v[60:61] op_sel_hi:[1,0]
  v_pk_mul_f32 v[54:55], v[54:55], v[60:61] op_sel_hi:[1,0]
  v_pk_mul_f32 v[56:57], v[56:57], v[60:61] op_sel_hi:[1,0]
  v_pk_mul_f32 v[58:59], v[58:59], v[60:61] op_sel_hi:[1,0]
  v_cvt_pk_bf16_f32 v36, v52, v53
  v_cvt_pk_bf16_f32 v37, v54, v55
  v_cvt_pk_bf16_f32 v38, v56, v57
  v_cvt_pk_bf16_f32 v39, v58, v59
  ds_write_b128 v15, v[36:39] offset:640
  v_lshlrev_b32 v44, 16, v40
  v_and_b32 v45, 0xffff0000, v40
  v_lshlrev_b32 v46, 16, v41
  v_and_b32 v47, 0xffff0000, v41
  v_lshlrev_b32 v48, 16, v42
  v_and_b32 v49, 0xffff0000, v42
  v_lshlrev_b32 v50, 16, v43
  v_and_b32 v51, 0xffff0000, v43
  v_pk_add_f32 v[44:45], v[44:45], v[6:7] op_sel_hi:[1,0]
  v_pk_add_f32 v[46:47], v[46:47], v[6:7] op_sel_hi:[1,0]
  v_pk_add_f32 v[48:49], v[48:49], v[6:7] op_sel_hi:[1,0]
  v_pk_add_f32 v[50:51], v[50:51], v[6:7] op_sel_hi:[1,0]
  v_cvt_pk_bf16_f32 v40, v44, v45
  v_cvt_pk_bf16_f32 v41, v46, v47
  v_cvt_pk_bf16_f32 v42, v48, v49
  v_cvt_pk_bf16_f32 v43, v50, v51
  v_lshlrev_b32 v44, 16, v40
  v_and_b32 v45, 0xffff0000, v40
  v_lshlrev_b32 v46, 16, v41
  v_and_b32 v47, 0xffff0000, v41
  v_lshlrev_b32 v48, 16, v42
  v_and_b32 v49, 0xffff0000, v42
  v_lshlrev_b32 v50, 16, v43
  v_and_b32 v51, 0xffff0000, v43
  v_pk_mul_f32 v[44:45], v[44:45], v[60:61] op_sel_hi:[1,0]
  v_pk_mul_f32 v[46:47], v[46:47], v[60:61] op_sel_hi:[1,0]
  v_pk_mul_f32 v[48:49], v[48:49], v[60:61] op_sel_hi:[1,0]
  v_pk_mul_f32 v[50:51], v[50:51], v[60:61] op_sel_hi:[1,0]
  v_cvt_pk_bf16_f32 v40, v44, v45
  v_cvt_pk_bf16_f32 v41, v46, v47
  v_cvt_pk_bf16_f32 v42, v48, v49
  v_cvt_pk_bf16_f32 v43, v50, v51
  ds_write_b128 v15, v[40:43] offset:768
  s_waitcnt lgkmcnt(0)
  s_barrier
  ds_read_b64_tr_b16 v[16:17], v14 offset:0
  ds_read_b64_tr_b16 v[18:19], v14 offset:3840
  ds_read_b64_tr_b16 v[20:21], v14 offset:16
  ds_read_b64_tr_b16 v[22:23], v14 offset:3856
  ds_read_b64_tr_b16 v[24:25], v14 offset:32
  ds_read_b64_tr_b16 v[26:27], v14 offset:3872
  ds_read_b64_tr_b16 v[28:29], v14 offset:48
  ds_read_b64_tr_b16 v[30:31], v14 offset:3888
  ds_read_b64_tr_b16 v[32:33], v14 offset:64
  ds_read_b64_tr_b16 v[34:35], v14 offset:3904
  ds_read_b64_tr_b16 v[36:37], v14 offset:80
  ds_read_b64_tr_b16 v[38:39], v14 offset:3920
  ds_read_b64_tr_b16 v[40:41], v14 offset:96
  ds_read_b64_tr_b16 v[42:43], v14 offset:3936
  v_and_b32 v4, 31, v0
  v_lshlrev_b32 v4, 4, v4
  v_lshrrev_b32 v5, 5, v0
  v_lshl_add_u32 v4, v5, 14, v4
  s_mul_i32 s42, s3, 229376
  s_lshl_b32 s43, s21, 9
  s_add_u32 s42, s42, s43
  s_add_u32 s42, s42, 2097152
  s_lshl_b32 s46, s37, 7
  s_add_u32 s46, s46, 229376
  s_waitcnt lgkmcnt(12)
  buffer_store_dwordx4 v[16:19], v4, s[16:19], s42 offen sc1
  s_add_u32 s42, s42, 32768
  s_waitcnt lgkmcnt(10)
  buffer_store_dwordx4 v[20:23], v4, s[16:19], s42 offen sc1
  s_add_u32 s42, s42, 32768
  s_waitcnt lgkmcnt(8)
  buffer_store_dwordx4 v[24:27], v4, s[16:19], s42 offen sc1
  s_add_u32 s42, s42, 32768
  s_waitcnt lgkmcnt(6)
  buffer_store_dwordx4 v[28:31], v4, s[16:19], s42 offen sc1
  s_add_u32 s42, s42, 32768
  s_waitcnt lgkmcnt(4)
  buffer_store_dwordx4 v[32:35], v4, s[16:19], s42 offen sc1
  s_add_u32 s42, s42, 32768
  s_waitcnt lgkmcnt(2)
  buffer_store_dwordx4 v[36:39], v4, s[16:19], s42 offen sc1
  s_add_u32 s42, s42, 32768
  s_waitcnt lgkmcnt(0)
  buffer_store_dwordx4 v[40:43], v4, s[16:19], s42 offen sc1
  s_add_u32 s42, s42, 32768
  s_waitcnt vmcnt(0)
  s_mov_b64 exec, 1
  v_mov_b32 v5, s20
  buffer_store_dword v5, off, s[16:19], s46 sc1
  s_mov_b64 exec, -1
  s_cmp_lg_u32 s21, 0
  s_cbranch_scc1 SV_3
  s_and_b32 s42, s3, 3
  v_lshl_add_u32 v4, s42, 6, v0
  v_mov_b32 v5, 393216
  v_mov_b32 v6, 200704
  v_cmp_gt_u32 vcc, 224, v4
  s_nop 1
  v_cndmask_b32 v5, v6, v5, vcc
  v_lshl_add_u32 v4, v4, 7, v5
  s_mov_b32 s57, 0
  buffer_load_dword v5, v4, s[16:19], 0 offen sc1
  s_waitcnt vmcnt(0)
  v_cmp_ne_u32 vcc, s20, v5
  s_cbranch_vccz PD_38
PL_37:
  buffer_load_dword v5, v4, s[16:19], 0 offen sc1
  s_add_u32 s57, s57, 1
  s_waitcnt vmcnt(0)
  v_cmp_ne_u32 vcc, s20, v5
  s_cbranch_vccz PD_38
  s_cmp_lt_u32 s57, 20000
  s_cbranch_scc1 PL_37
PD_38:
  s_barrier
  s_cmp_lg_u32 s3, 0
  s_cbranch_scc1 SV_3
  s_mov_b32 s42, 0
  s_mov_b64 exec, 1
  v_mov_b32 v5, s20
  buffer_store_dword v5, off, s[16:19], s42 sc1
  s_mov_b64 exec, -1
SV_3:
  s_endpgm
CODEEND:
.section .rodata,"a"
.p2align 6
.amdhsa_kernel recurrent_scan__ssm_conv_s4__glu_gated_glu__prompt_kernel
  .amdhsa_next_free_vgpr 256
  .amdhsa_next_free_sgpr 102
  .amdhsa_accum_offset 256
  .amdhsa_group_segment_fixed_size 0
  .amdhsa_kernarg_size 128
  .amdhsa_user_sgpr_count 2
  .amdhsa_user_sgpr_kernarg_segment_ptr 1
  .amdhsa_system_sgpr_workgroup_id_x 1
.end_amdhsa_kernel
```
